```python
import torch

def _softmax(x, axis=-1):
    return torch.softmax(x, dim=axis)
def _gelu(x):
    return torch.nn.functional.gelu(x, approximate="tanh")
def _silu(x):
    return torch.nn.functional.silu(x)
def _sigmoid(x):
    return torch.sigmoid(x)
def _layernorm(x, axis=-1, eps=1e-5):
    m = x.mean(dim=axis, keepdim=True)
    v = x.var(dim=axis, keepdim=True, unbiased=False)
    return (x - m) / torch.sqrt(v + eps)
def _scatter_add(tgt, idx, src, axis=0):
    return tgt.clone().index_add_(axis, idx, src)
def _segment_sum(src, seg, n):
    out = torch.zeros((n,) + src.shape[1:], dtype=src.dtype)
    return out.index_add_(0, seg, src)
def _pad(x, pw):
    flat = tuple(v for pair in reversed(pw) for v in pair)
    return torch.nn.functional.pad(x, flat)

kernel_name = 'parallel_sum__sliding_local_dilated__dense_activation_relu__prompt'

def setup_inputs():

    _w = (lambda a: (lambda t: t.to(torch.bfloat16) if t.is_floating_point() else t)(torch.as_tensor(a)))
    def _A_setup():
        B, S, D = 1, 2048, 1024
        return {
            "x": _w((lambda *s: torch.randn(*s, dtype=torch.bfloat16) * 0.05)(B, S, D)),
            "wqkv": _w((lambda *s: torch.randn(*s, dtype=torch.bfloat16) * 0.05)(D, 3 * D)),
            "wo": _w((lambda *s: torch.randn(*s, dtype=torch.bfloat16) * 0.05)(D, D)),
        }
    _A_in = _A_setup()

    def _B_setup():
        B, S, D, Dff = 1, 2048, 1024, 3584
        return {
            "x": _w((lambda *s: torch.randn(*s, dtype=torch.bfloat16) * 0.05)(B, S, D)),
            "w1": _w((lambda *s: torch.randn(*s, dtype=torch.bfloat16) * 0.05)(D, Dff)),
            "w2": _w((lambda *s: torch.randn(*s, dtype=torch.bfloat16) * 0.05)(Dff, D)),
        }
    _B_in = _B_setup()

    return {
        "A_x": _A_in["x"],
        "A_wqkv": _A_in["wqkv"],
        "A_wo": _A_in["wo"],
        "B_x": _B_in["x"],
        "B_w1": _B_in["w1"],
        "B_w2": _B_in["w2"],
    }

def reference(A_x, A_wqkv, A_wo, B_x, B_w1, B_w2):
    def _A_ref(x, wqkv, wo):
        B, S, D = x.shape
        H = 32; Dh = D // H
        W, dil = 8, 2
        qkv = (lambda x, *d: x.permute(*d))((x @ wqkv).reshape(B, S, 3, H, Dh), 2, 0, 3, 1, 4)
        q, k, v = qkv[0], qkv[1], qkv[2]
        scale = Dh ** -0.5
        pos = torch.arange(S)
        off = torch.arange(W) * dil
        idx = pos[:, None] - off[None, :]
        mask = idx >= 0
        idx_c = torch.where(mask, idx, 0).reshape(-1)
        kg = k[:, :, idx_c, :].reshape(B, H, S, W, Dh)
        vg = v[:, :, idx_c, :].reshape(B, H, S, W, Dh)
        logits = torch.einsum("bhsd,bhswd->bhsw", q, kg) * scale
        logits = torch.where(mask[None, None, :, :], logits, -1e9)
        attn = _softmax(logits, axis=-1)
        o = torch.einsum("bhsw,bhswd->bhsd", attn, vg)
        return (lambda x, *d: x.permute(*d))(o, 0, 2, 1, 3).reshape(B, S, D) @ wo

    def _B_ref(x, w1, w2):
        h = torch.einsum("bsd,df->bsf", x, w1)
        zero = torch.zeros_like(h)
        h = torch.maximum(h, zero)
        return torch.einsum("bsf,fd->bsd", h, w2)

    x = A_x
    xn = _layernorm(x, axis=-1)
    return x + _A_ref(xn, A_wqkv, A_wo) + _B_ref(xn, B_w1, B_w2)
```

```asm
; @launch kernel=g1_kernel grid=(256,1,1) block=(512,1,1) lds=163840
; @launch kernel=g2_kernel grid=(256,1,1) block=(512,1,1) lds=163840
.amdgcn_target "amdgcn-amd-amdhsa--gfx950"
.text

.globl g1_kernel
.p2align 8
.type g1_kernel,@function
g1_kernel:
    s_cmp_ge_u32 s2, 256
    s_cbranch_scc1 g1_exit
    s_load_dwordx4 s[4:7], s[0:1], 0
    s_load_dwordx2 s[10:11], s[0:1], 32
    s_load_dwordx2 s[8:9], s[0:1], 64
    s_load_dwordx2 s[92:93], s[0:1], 16
    s_load_dwordx2 s[78:79], s[0:1], 56
    s_load_dwordx2 s[94:95], s[0:1], 40
    v_and_b32 v250, 63, v0
    v_lshrrev_b32 v236, 6, v0
    v_and_b32 v251, 15, v0
    v_readfirstlane_b32 s24, v236
    v_bfe_u32 v252, v0, 4, 2
    s_nop 2
    s_cmp_lg_u32 s24, 7
    s_cbranch_scc1 g1_nopf
    s_getpc_b64 s[62:63]
g1_kernel_pc:
    s_add_u32 s62, s62, g1_kernel-g1_kernel_pc
    s_addc_u32 s63, s63, -1
    v_lshlrev_b32 v238, 7, v250
    v_min_u32 v239, g1_end-g1_kernel-4, v238
    global_load_dword v255, v239, s[62:63]
    v_add_u32 v238, 0x2000, v238
    v_min_u32 v239, g1_end-g1_kernel-4, v238
    global_load_dword v255, v239, s[62:63]
    v_add_u32 v238, 0x2000, v238
    v_min_u32 v239, g1_end-g1_kernel-4, v238
    global_load_dword v255, v239, s[62:63]
g1_nopf:
    s_and_b32 s39, s2, 7
    s_lshr_b32 s42, s2, 3
    s_and_b32 s29, s39, 1
    s_lshl_b32 s29, s29, 2
    s_and_b32 s43, s42, 3
    s_add_u32 s29, s29, s43
    s_lshr_b32 s42, s42, 2
    s_lshr_b32 s39, s39, 1
    s_lshl_b32 s30, s39, 2
    s_and_b32 s43, s42, 3
    s_add_u32 s30, s30, s43
    s_lshr_b32 s42, s42, 2
    s_and_b32 s28, s24, 3
    s_and_b32 s27, s24, 1
    s_bfe_u32 s26, s24, 0x10001
    s_lshr_b32 s43, s24, 2
    s_lshl_b32 s80, s2, 3
    s_add_u32 s80, s80, s24
    v_lshlrev_b32 v216, 4, v250
    s_waitcnt lgkmcnt(0)
    s_add_u32 s12, s4, 0
    s_addc_u32 s13, s5, 0
    s_and_b32 s13, s13, 0xffff
    s_mov_b32 s14, 4194304
    s_mov_b32 s15, 0x20000
    s_mov_b32 s96, s12
    s_mov_b32 s97, s13
    s_mov_b32 s98, 4194304
    s_mov_b32 s99, 0x20000
    s_mov_b32 s20, s8
    s_and_b32 s21, s9, 0xffff
    s_mov_b32 s22, 18874368
    s_mov_b32 s23, 0x20000
    s_lshl_b32 s42, s42, 1
    s_add_u32 s42, s42, s43
    s_cmp_lg_u32 s2, 255
    s_cbranch_scc1 g1_noz
    s_add_u32 s64, s8, 31457280
    s_addc_u32 s65, s9, 0
    s_and_b32 s65, s65, 0xffff
    s_mov_b32 s66, 8192
    s_mov_b32 s67, 0x20000
    v_lshlrev_b32 v236, 4, v0
    v_mov_b32 v4, 0
    v_mov_b32 v5, 0
    v_mov_b32 v6, 0
    v_mov_b32 v7, 0
    buffer_store_dwordx4 v[4:7], v236, s[64:67], 0 offen
g1_noz:
    s_cmp_eq_u32 s42, 0
    s_cbranch_scc1 g1_00
    s_cmp_eq_u32 s42, 1
    s_cbranch_scc1 g1_01
    s_cmp_eq_u32 s42, 2
    s_cbranch_scc1 g1_10
    s_branch g1_11
g1_exit:
    s_endpgm
g1_00:
    s_mov_b32 s16, s6
    s_and_b32 s17, s7, 0xffff
    s_mov_b32 s18, 6291456
    s_mov_b32 s19, 0x20000
    v_lshrrev_b32 v236, 3, v250
    v_and_b32 v237, 7, v250
    v_xor_b32 v237, v237, v236
    s_lshl_b32 s39, s29, 8
    s_lshl_b32 s42, s28, 5
    s_add_u32 s39, s39, s42
    s_add_u32 s39, s39, 128
    v_add_u32 v238, s39, v236
    v_lshlrev_b32 v238, 11, v238
    v_lshl_add_u32 v230, v237, 4, v238
    s_and_b32 s42, s28, 1
    s_lshl_b32 s42, s42, 3
    v_add_u32 v238, s42, v236
    s_lshl_b32 s39, s29, 8
    s_sub_u32 s39, s39, 16
    v_add_u32 v238, s39, v238
    v_max_i32 v238, 0, v238
    v_lshlrev_b32 v238, 11, v238
    v_lshl_add_u32 v235, v237, 4, v238
    s_mul_i32 s61, s28, 3072
    s_sub_u32 s61, 24576, s61
    s_lshl_b32 s42, s42, 7
    s_add_u32 s61, s61, s42
    s_mul_i32 s43, s28, 192
    s_add_u32 s39, s43, 0
    v_add_u32 v236, s39, v250
    v_mul_u32_u24 v237, 2731, v236
    v_lshrrev_b32 v237, 16, v237
    v_mul_u32_u24 v238, 24, v237
    v_sub_u32 v238, v236, v238
    v_bfe_u32 v239, v237, 1, 1
    v_bfe_u32 v240, v237, 3, 1
    v_lshl_or_b32 v239, v240, 1, v239
    v_lshrrev_b32 v240, 1, v238
    v_xor_b32 v240, v240, v239
    v_cmp_le_u32 vcc, 6, v240
    s_nop 1
    v_cndmask_b32 v241, 0, 1, vcc
    v_mul_u32_u24 v242, 6, v241
    v_sub_u32 v242, v240, v242
    v_lshrrev_b32 v243, 1, v242
    v_and_b32 v242, 1, v242
    v_lshlrev_b32 v243, 11, v243
    v_lshl_add_u32 v243, v241, 6, v243
    v_lshl_add_u32 v243, v242, 5, v243
    v_and_b32 v242, 1, v238
    v_lshl_add_u32 v243, v242, 4, v243
    s_lshl_b32 s39, s30, 7
    v_add_u32 v243, s39, v243
    v_mul_u32_u24 v237, 6144, v237
    v_add_u32 v231, v237, v243
    s_add_u32 s39, s43, 64
    v_add_u32 v236, s39, v250
    v_mul_u32_u24 v237, 2731, v236
    v_lshrrev_b32 v237, 16, v237
    v_mul_u32_u24 v238, 24, v237
    v_sub_u32 v238, v236, v238
    v_bfe_u32 v239, v237, 1, 1
    v_bfe_u32 v240, v237, 3, 1
    v_lshl_or_b32 v239, v240, 1, v239
    v_lshrrev_b32 v240, 1, v238
    v_xor_b32 v240, v240, v239
    v_cmp_le_u32 vcc, 6, v240
    s_nop 1
    v_cndmask_b32 v241, 0, 1, vcc
    v_mul_u32_u24 v242, 6, v241
    v_sub_u32 v242, v240, v242
    v_lshrrev_b32 v243, 1, v242
    v_and_b32 v242, 1, v242
    v_lshlrev_b32 v243, 11, v243
    v_lshl_add_u32 v243, v241, 6, v243
    v_lshl_add_u32 v243, v242, 5, v243
    v_and_b32 v242, 1, v238
    v_lshl_add_u32 v243, v242, 4, v243
    s_lshl_b32 s39, s30, 7
    v_add_u32 v243, s39, v243
    v_mul_u32_u24 v237, 6144, v237
    v_add_u32 v232, v237, v243
    s_add_u32 s39, s43, 128
    v_add_u32 v236, s39, v250
    v_mul_u32_u24 v237, 2731, v236
    v_lshrrev_b32 v237, 16, v237
    v_mul_u32_u24 v238, 24, v237
    v_sub_u32 v238, v236, v238
    v_bfe_u32 v239, v237, 1, 1
    v_bfe_u32 v240, v237, 3, 1
    v_lshl_or_b32 v239, v240, 1, v239
    v_lshrrev_b32 v240, 1, v238
    v_xor_b32 v240, v240, v239
    v_cmp_le_u32 vcc, 6, v240
    s_nop 1
    v_cndmask_b32 v241, 0, 1, vcc
    v_mul_u32_u24 v242, 6, v241
    v_sub_u32 v242, v240, v242
    v_lshrrev_b32 v243, 1, v242
    v_and_b32 v242, 1, v242
    v_lshlrev_b32 v243, 11, v243
    v_lshl_add_u32 v243, v241, 6, v243
    v_lshl_add_u32 v243, v242, 5, v243
    v_and_b32 v242, 1, v238
    v_lshl_add_u32 v243, v242, 4, v243
    s_lshl_b32 s39, s30, 7
    v_add_u32 v243, s39, v243
    v_mul_u32_u24 v237, 6144, v237
    v_add_u32 v233, v237, v243
    s_lshl_b32 s32, s29, 8
    s_and_b32 s32, s32, 0x7ff
    s_mul_i32 s33, s29, 786432
    s_mov_b32 s41, s32
    s_lshl_b32 s34, s28, 12
    s_add_u32 s34, s34, 32768
    s_mul_i32 s35, s28, 3072
    s_add_u32 s35, s35, 65536
    s_mov_b32 s37, 0
    s_add_u32 m0, s35, 0
    s_nop 0
    buffer_load_dwordx4 v231, s[16:19], s33 offen lds
    s_add_u32 m0, s35, 1024
    s_nop 0
    buffer_load_dwordx4 v232, s[16:19], s33 offen lds
    s_add_u32 m0, s35, 2048
    s_nop 0
    buffer_load_dwordx4 v233, s[16:19], s33 offen lds
    s_add_u32 m0, s35, s61
    s_nop 0
    buffer_load_dwordx4 v235, s[12:15], s41 offen lds
    s_add_u32 s41, s41, 128
    s_and_b32 s41, s41, 0x7ff
    s_add_u32 s33, s33, 393216
    s_cmp_eq_u32 s33, 6291456
    s_cselect_b32 s33, 0, s33
    s_add_u32 s37, s37, 1
    s_add_u32 s35, s35, 28672
    s_cmp_eq_u32 s37, 3
    s_cselect_b32 s39, 86016, 0
    s_cselect_b32 s37, 0, s37
    s_sub_u32 s35, s35, s39
    s_add_u32 m0, s34, 0
    s_add_u32 s39, s32, 0
    buffer_load_dwordx4 v230, s[96:99], s39 offen lds
    s_add_u32 m0, s34, 1024
    s_add_u32 s39, s32, 16384
    buffer_load_dwordx4 v230, s[96:99], s39 offen lds
    s_add_u32 m0, s34, 2048
    s_add_u32 s39, s32, 32768
    buffer_load_dwordx4 v230, s[96:99], s39 offen lds
    s_add_u32 m0, s34, 3072
    s_add_u32 s39, s32, 49152
    buffer_load_dwordx4 v230, s[96:99], s39 offen lds
    s_add_u32 s32, s32, 128
    s_and_b32 s32, s32, 0x7ff
    s_xor_b32 s34, s34, 16384
    s_add_u32 m0, s35, 0
    s_nop 0
    buffer_load_dwordx4 v231, s[16:19], s33 offen lds
    s_add_u32 m0, s35, 1024
    s_nop 0
    buffer_load_dwordx4 v232, s[16:19], s33 offen lds
    s_add_u32 m0, s35, 2048
    s_nop 0
    buffer_load_dwordx4 v233, s[16:19], s33 offen lds
    s_add_u32 m0, s35, s61
    s_nop 0
    buffer_load_dwordx4 v235, s[12:15], s41 offen lds
    s_add_u32 s41, s41, 128
    s_and_b32 s41, s41, 0x7ff
    s_add_u32 s33, s33, 393216
    s_cmp_eq_u32 s33, 6291456
    s_cselect_b32 s33, 0, s33
    s_add_u32 s37, s37, 1
    s_add_u32 s35, s35, 28672
    s_cmp_eq_u32 s37, 3
    s_cselect_b32 s39, 86016, 0
    s_cselect_b32 s37, 0, s37
    s_sub_u32 s35, s35, s39
    s_and_b32 s93, s93, 0xffff
    s_and_b32 s95, s95, 0xffff
    s_lshl_b32 s70, s2, 3
    s_add_u32 s70, s70, s24
    s_lshl_b32 s70, s70, 10
    v_lshlrev_b32 v216, 4, v250
    s_mov_b32 s71, 786432
    s_mov_b32 s91, 0
    s_add_u32 s64, s8, 29360128
    s_addc_u32 s65, s9, 0
    s_and_b32 s65, s65, 0xffff
    s_mov_b32 s66, 327680
    s_mov_b32 s67, 0x20000
    s_mov_b32 s72, s78
    s_and_b32 s73, s79, 0xffff
    s_mov_b32 s74, 256
    s_mov_b32 s75, 0x20000
    s_add_u32 s76, s30, 0
    s_mov_b32 s77, 53284
    s_mul_i32 s39, s27, 6
    s_lshl_b32 s42, s26, 1
    s_add_u32 s44, s39, s42
    s_add_u32 s44, s44, 2
    s_add_u32 s45, s44, 1
    s_mov_b32 s46, s39
    s_add_u32 s47, s39, 1
    s_sub_u32 s48, s39, s42
    s_add_u32 s48, s48, 4
    s_add_u32 s49, s48, 1
    v_and_b32 v236, 7, v251
    v_xor_b32 v236, v252, v236
    v_lshlrev_b32 v236, 4, v236
    v_lshl_add_u32 v236, v251, 7, v236
    s_lshl_b32 s39, s26, 13
    s_add_u32 s39, s39, 0
    s_lshl_b32 s42, s27, 12
    s_add_u32 s43, s39, s42
    v_add_u32 v217, s43, v236
    v_xor_b32 v218, 64, v217
    s_xor_b32 s42, s42, 4096
    s_add_u32 s43, s39, s42
    v_add_u32 v219, s43, v236
    v_xor_b32 v220, 64, v219
    v_add_u32 v228, 90112, v236
    v_xor_b32 v229, 64, v228
    v_lshrrev_b32 v236, 2, v251
    v_lshl_add_u32 v237, v252, 3, v236
    v_mul_u32_u24 v237, 384, v237
    v_and_b32 v238, 3, v250
    v_lshl_add_u32 v237, v238, 3, v237
    v_add_u32 v237, 65536, v237
    v_and_b32 v238, 1, v252
    v_lshrrev_b32 v239, 1, v236
    v_lshl_or_b32 v238, v238, 1, v239
    v_xor_b32 v239, s44, v238
    v_lshl_add_u32 v221, v239, 5, v237
    v_xor_b32 v239, s45, v238
    v_lshl_add_u32 v222, v239, 5, v237
    v_xor_b32 v239, s46, v238
    v_lshl_add_u32 v223, v239, 5, v237
    v_xor_b32 v239, s47, v238
    v_lshl_add_u32 v224, v239, 5, v237
    v_xor_b32 v239, s48, v238
    v_lshl_add_u32 v225, v239, 5, v237
    v_xor_b32 v239, s49, v238
    v_lshl_add_u32 v226, v239, 5, v237
    v_mov_b32 v0, 0
    v_mov_b32 v1, 0
    v_mov_b32 v2, 0
    v_mov_b32 v3, 0
    v_mov_b32 v4, 0
    v_mov_b32 v5, 0
    v_mov_b32 v6, 0
    v_mov_b32 v7, 0
    v_mov_b32 v8, 0
    v_mov_b32 v9, 0
    v_mov_b32 v10, 0
    v_mov_b32 v11, 0
    v_mov_b32 v12, 0
    v_mov_b32 v13, 0
    v_mov_b32 v14, 0
    v_mov_b32 v15, 0
    v_mov_b32 v16, 0
    v_mov_b32 v17, 0
    v_mov_b32 v18, 0
    v_mov_b32 v19, 0
    v_mov_b32 v20, 0
    v_mov_b32 v21, 0
    v_mov_b32 v22, 0
    v_mov_b32 v23, 0
    v_mov_b32 v24, 0
    v_mov_b32 v25, 0
    v_mov_b32 v26, 0
    v_mov_b32 v27, 0
    v_mov_b32 v28, 0
    v_mov_b32 v29, 0
    v_mov_b32 v30, 0
    v_mov_b32 v31, 0
    v_mov_b32 v32, 0
    v_mov_b32 v33, 0
    v_mov_b32 v34, 0
    v_mov_b32 v35, 0
    v_mov_b32 v36, 0
    v_mov_b32 v37, 0
    v_mov_b32 v38, 0
    v_mov_b32 v39, 0
    v_mov_b32 v40, 0
    v_mov_b32 v41, 0
    v_mov_b32 v42, 0
    v_mov_b32 v43, 0
    v_mov_b32 v44, 0
    v_mov_b32 v45, 0
    v_mov_b32 v46, 0
    v_mov_b32 v47, 0
    v_mov_b32 v48, 0
    v_mov_b32 v49, 0
    v_mov_b32 v50, 0
    v_mov_b32 v51, 0
    v_mov_b32 v52, 0
    v_mov_b32 v53, 0
    v_mov_b32 v54, 0
    v_mov_b32 v55, 0
    v_mov_b32 v56, 0
    v_mov_b32 v57, 0
    v_mov_b32 v58, 0
    v_mov_b32 v59, 0
    v_mov_b32 v60, 0
    v_mov_b32 v61, 0
    v_mov_b32 v62, 0
    v_mov_b32 v63, 0
    v_mov_b32 v64, 0
    v_mov_b32 v65, 0
    v_mov_b32 v66, 0
    v_mov_b32 v67, 0
    v_mov_b32 v68, 0
    v_mov_b32 v69, 0
    v_mov_b32 v70, 0
    v_mov_b32 v71, 0
    v_mov_b32 v72, 0
    v_mov_b32 v73, 0
    v_mov_b32 v74, 0
    v_mov_b32 v75, 0
    v_mov_b32 v76, 0
    v_mov_b32 v77, 0
    v_mov_b32 v78, 0
    v_mov_b32 v79, 0
    v_mov_b32 v80, 0
    v_mov_b32 v81, 0
    v_mov_b32 v82, 0
    v_mov_b32 v83, 0
    v_mov_b32 v84, 0
    v_mov_b32 v85, 0
    v_mov_b32 v86, 0
    v_mov_b32 v87, 0
    v_mov_b32 v88, 0
    v_mov_b32 v89, 0
    v_mov_b32 v90, 0
    v_mov_b32 v91, 0
    v_mov_b32 v92, 0
    v_mov_b32 v93, 0
    v_mov_b32 v94, 0
    v_mov_b32 v95, 0
    v_mov_b32 v96, 0
    v_mov_b32 v97, 0
    v_mov_b32 v98, 0
    v_mov_b32 v99, 0
    v_mov_b32 v100, 0
    v_mov_b32 v101, 0
    v_mov_b32 v102, 0
    v_mov_b32 v103, 0
    v_mov_b32 v208, 0
    v_mov_b32 v209, 0
    v_mov_b32 v210, 0
    v_mov_b32 v211, 0
    v_mov_b32 v212, 0
    v_mov_b32 v213, 0
    v_mov_b32 v214, 0
    v_mov_b32 v215, 0
    v_mov_b32 v240, 0x3f803f80
    v_mov_b32 v241, 0x3f803f80
    v_mov_b32 v242, 0x3f803f80
    v_mov_b32 v243, 0x3f803f80
    s_mov_b32 s60, 28672
    s_mov_b32 s31, 0
    s_mov_b32 s38, 0
    s_waitcnt vmcnt(8)
    s_barrier
    s_mov_b32 s25, s34
    s_mov_b32 s3, s35
.p2align 6
g1_00_loop:
    ds_read_b128 v[112:115], v217 offset:0
    ds_read_b128 v[120:123], v217 offset:2048
    s_add_u32 m0, s25, 0
    s_add_u32 s39, s32, 0
    buffer_load_dwordx4 v230, s[96:99], s39 offen lds
    ds_read_b128 v[128:131], v219 offset:0
    ds_read_b128 v[136:139], v219 offset:2048
    ds_read_b128 v[200:203], v228
    ds_read_b64_tr_b16 v[144:145], v221 offset:0
    s_add_u32 m0, s25, 1024
    s_add_u32 s39, s32, 16384
    buffer_load_dwordx4 v230, s[96:99], s39 offen lds
    ds_read_b64_tr_b16 v[146:147], v221 offset:1536
    ds_read_b64_tr_b16 v[152:153], v222 offset:0
    ds_read_b64_tr_b16 v[154:155], v222 offset:1536
    ds_read_b64_tr_b16 v[160:161], v223 offset:0
    s_add_u32 m0, s25, 2048
    s_add_u32 s39, s32, 32768
    buffer_load_dwordx4 v230, s[96:99], s39 offen lds
    ds_read_b64_tr_b16 v[162:163], v223 offset:1536
    ds_read_b64_tr_b16 v[168:169], v224 offset:0
    ds_read_b64_tr_b16 v[170:171], v224 offset:1536
    ds_read_b64_tr_b16 v[176:177], v225 offset:0
    s_add_u32 m0, s25, 3072
    s_add_u32 s39, s32, 49152
    buffer_load_dwordx4 v230, s[96:99], s39 offen lds
    ds_read_b64_tr_b16 v[178:179], v225 offset:1536
    ds_read_b64_tr_b16 v[184:185], v226 offset:0
    ds_read_b64_tr_b16 v[186:187], v226 offset:1536
    ds_read_b128 v[116:119], v218 offset:0
    s_add_u32 m0, s3, 0
    s_nop 0
    buffer_load_dwordx4 v231, s[16:19], s33 offen lds
    ds_read_b128 v[124:127], v218 offset:2048
    ds_read_b128 v[132:135], v220 offset:0
    ds_read_b128 v[140:143], v220 offset:2048
    ds_read_b128 v[204:207], v229
    s_add_u32 m0, s3, 1024
    s_nop 0
    buffer_load_dwordx4 v232, s[16:19], s33 offen lds
    ds_read_b64_tr_b16 v[148:149], v221 offset:12288
    ds_read_b64_tr_b16 v[150:151], v221 offset:13824
    ds_read_b64_tr_b16 v[156:157], v222 offset:12288
    ds_read_b64_tr_b16 v[158:159], v222 offset:13824
    s_add_u32 m0, s3, 2048
    s_nop 0
    buffer_load_dwordx4 v233, s[16:19], s33 offen lds
    ds_read_b64_tr_b16 v[164:165], v223 offset:12288
    ds_read_b64_tr_b16 v[166:167], v223 offset:13824
    ds_read_b64_tr_b16 v[172:173], v224 offset:12288
    ds_read_b64_tr_b16 v[174:175], v224 offset:13824
    s_add_u32 m0, s3, s61
    s_nop 0
    buffer_load_dwordx4 v235, s[12:15], s41 offen lds
    ds_read_b64_tr_b16 v[180:181], v225 offset:12288
    ds_read_b64_tr_b16 v[182:183], v225 offset:13824
    ds_read_b64_tr_b16 v[188:189], v226 offset:12288
    ds_read_b64_tr_b16 v[190:191], v226 offset:13824
    s_bitcmp1_b32 s77, s31
    s_cbranch_scc1 g1_00_event
    s_waitcnt vmcnt(8) lgkmcnt(0)
g1_00_afterwait:
    s_barrier
    s_setprio 1
    v_mfma_f32_16x16x32_bf16 v[0:3], v[144:147], v[112:115], v[0:3]
    v_mfma_f32_16x16x32_bf16 v[4:7], v[144:147], v[120:123], v[4:7]
    v_mfma_f32_16x16x32_bf16 v[8:11], v[144:147], v[128:131], v[8:11]
    s_add_u32 s32, s32, 128
    v_mfma_f32_16x16x32_bf16 v[12:15], v[144:147], v[136:139], v[12:15]
    s_and_b32 s32, s32, 0x7ff
    v_mfma_f32_16x16x32_bf16 v[16:19], v[152:155], v[112:115], v[16:19]
    s_xor_b32 s34, s34, 16384
    v_mfma_f32_16x16x32_bf16 v[20:23], v[152:155], v[120:123], v[20:23]
    s_cmp_ge_u32 s31, 14
    v_mfma_f32_16x16x32_bf16 v[24:27], v[152:155], v[128:131], v[24:27]
    s_cselect_b32 s98, 0, s98
    v_mfma_f32_16x16x32_bf16 v[28:31], v[152:155], v[136:139], v[28:31]
    s_cselect_b32 s25, 163840, s34
    v_mfma_f32_16x16x32_bf16 v[32:35], v[160:163], v[112:115], v[32:35]
    s_add_u32 s41, s41, 128
    v_mfma_f32_16x16x32_bf16 v[36:39], v[160:163], v[120:123], v[36:39]
    s_and_b32 s41, s41, 0x7ff
    v_mfma_f32_16x16x32_bf16 v[40:43], v[160:163], v[128:131], v[40:43]
    s_add_u32 s91, s91, s71
    v_mfma_f32_16x16x32_bf16 v[44:47], v[160:163], v[136:139], v[44:47]
    s_add_u32 s33, s33, 393216
    v_mfma_f32_16x16x32_bf16 v[48:51], v[168:171], v[112:115], v[48:51]
    s_cmp_eq_u32 s33, 6291456
    v_mfma_f32_16x16x32_bf16 v[52:55], v[168:171], v[120:123], v[52:55]
    s_cselect_b32 s33, 0, s33
    v_mfma_f32_16x16x32_bf16 v[56:59], v[168:171], v[128:131], v[56:59]
    s_add_u32 s37, s37, 1
    v_mfma_f32_16x16x32_bf16 v[60:63], v[168:171], v[136:139], v[60:63]
    s_add_u32 s35, s35, 28672
    v_mfma_f32_16x16x32_bf16 v[64:67], v[176:179], v[112:115], v[64:67]
    s_cmp_eq_u32 s37, 3
    v_mfma_f32_16x16x32_bf16 v[68:71], v[176:179], v[120:123], v[68:71]
    s_cselect_b32 s39, 86016, 0
    v_mfma_f32_16x16x32_bf16 v[72:75], v[176:179], v[128:131], v[72:75]
    s_cselect_b32 s37, 0, s37
    v_mfma_f32_16x16x32_bf16 v[76:79], v[176:179], v[136:139], v[76:79]
    s_sub_u32 s35, s35, s39
    v_mfma_f32_16x16x32_bf16 v[80:83], v[184:187], v[112:115], v[80:83]
    s_cmp_ge_u32 s31, 13
    v_mfma_f32_16x16x32_bf16 v[84:87], v[184:187], v[120:123], v[84:87]
    s_cselect_b32 s3, 163840, s35
    v_mfma_f32_16x16x32_bf16 v[88:91], v[184:187], v[128:131], v[88:91]
    s_cselect_b32 s18, 0, s18
    v_mfma_f32_16x16x32_bf16 v[92:95], v[184:187], v[136:139], v[92:95]
    s_cselect_b32 s14, 0, s14
    v_mfma_f32_16x16x32_bf16 v[96:99], v[144:147], v[200:203], v[96:99]
    s_add_u32 s38, s38, 1
    v_mfma_f32_16x16x32_bf16 v[100:103], v[152:155], v[200:203], v[100:103]
    s_cmp_eq_u32 s38, 3
    v_mfma_f32_16x16x32_bf16 v[0:3], v[148:151], v[116:119], v[0:3]
    s_cselect_b32 s36, 4294909952, s60
    v_mfma_f32_16x16x32_bf16 v[4:7], v[148:151], v[124:127], v[4:7]
    s_cselect_b32 s38, 0, s38
    v_mfma_f32_16x16x32_bf16 v[8:11], v[148:151], v[132:135], v[8:11]
    v_xor_b32 v217, 16384, v217
    v_mfma_f32_16x16x32_bf16 v[12:15], v[148:151], v[140:143], v[12:15]
    v_xor_b32 v218, 16384, v218
    v_mfma_f32_16x16x32_bf16 v[16:19], v[156:159], v[116:119], v[16:19]
    v_xor_b32 v219, 16384, v219
    v_mfma_f32_16x16x32_bf16 v[20:23], v[156:159], v[124:127], v[20:23]
    v_xor_b32 v220, 16384, v220
    v_mfma_f32_16x16x32_bf16 v[24:27], v[156:159], v[132:135], v[24:27]
    v_add_u32 v221, s36, v221
    v_mfma_f32_16x16x32_bf16 v[28:31], v[156:159], v[140:143], v[28:31]
    v_add_u32 v222, s36, v222
    v_mfma_f32_16x16x32_bf16 v[32:35], v[164:167], v[116:119], v[32:35]
    v_add_u32 v223, s36, v223
    v_mfma_f32_16x16x32_bf16 v[36:39], v[164:167], v[124:127], v[36:39]
    v_add_u32 v224, s36, v224
    v_mfma_f32_16x16x32_bf16 v[40:43], v[164:167], v[132:135], v[40:43]
    v_add_u32 v225, s36, v225
    v_mfma_f32_16x16x32_bf16 v[44:47], v[164:167], v[140:143], v[44:47]
    v_add_u32 v226, s36, v226
    v_mfma_f32_16x16x32_bf16 v[48:51], v[172:175], v[116:119], v[48:51]
    v_add_u32 v228, s36, v228
    v_mfma_f32_16x16x32_bf16 v[52:55], v[172:175], v[124:127], v[52:55]
    v_add_u32 v229, s36, v229
    v_mfma_f32_16x16x32_bf16 v[56:59], v[172:175], v[132:135], v[56:59]
    v_mfma_f32_16x16x32_bf16 v[60:63], v[172:175], v[140:143], v[60:63]
    v_mfma_f32_16x16x32_bf16 v[64:67], v[180:183], v[116:119], v[64:67]
    v_mfma_f32_16x16x32_bf16 v[68:71], v[180:183], v[124:127], v[68:71]
    v_mfma_f32_16x16x32_bf16 v[72:75], v[180:183], v[132:135], v[72:75]
    v_mfma_f32_16x16x32_bf16 v[76:79], v[180:183], v[140:143], v[76:79]
    v_mfma_f32_16x16x32_bf16 v[80:83], v[188:191], v[116:119], v[80:83]
    v_mfma_f32_16x16x32_bf16 v[84:87], v[188:191], v[124:127], v[84:87]
    v_mfma_f32_16x16x32_bf16 v[88:91], v[188:191], v[132:135], v[88:91]
    v_mfma_f32_16x16x32_bf16 v[92:95], v[188:191], v[140:143], v[92:95]
    v_mfma_f32_16x16x32_bf16 v[96:99], v[148:151], v[204:207], v[96:99]
    v_mfma_f32_16x16x32_bf16 v[100:103], v[156:159], v[204:207], v[100:103]
    s_cmp_lt_u32 s31, 2
    s_cbranch_scc0 g1_00_nocs
    v_mfma_f32_16x16x32_bf16 v[208:211], v[144:147], v[240:243], v[208:211]
    v_mfma_f32_16x16x32_bf16 v[212:215], v[152:155], v[240:243], v[212:215]
    v_mfma_f32_16x16x32_bf16 v[208:211], v[148:151], v[240:243], v[208:211]
    v_mfma_f32_16x16x32_bf16 v[212:215], v[156:159], v[240:243], v[212:215]
g1_00_nocs:
    s_setprio 0
    s_add_u32 s31, s31, 1
    s_cmp_lt_u32 s31, 16
    s_barrier
    s_cbranch_scc1 g1_00_loop
    s_branch g1_00_post
g1_00_event:
    s_cmp_eq_u32 s31, 15
    s_cbranch_scc0 g1_00_evn15
    s_waitcnt vmcnt(13) lgkmcnt(0)
    s_branch g1_00_afterwait
g1_00_evn15:
g1_00_ev2:
    s_cmp_eq_u32 s31, 2
    s_cbranch_scc0 g1_00_ev5
    v_lshlrev_b32 v236, 24, v251
    v_lshl_add_u32 v236, v252, 4, v236
    s_lshl_b32 s42, s76, 3
    s_add_u32 s42, s42, s29
    s_lshl_b32 s42, s42, 10
    s_add_u32 s42, s42, 65536
    s_lshl_b32 s39, s44, 6
    s_add_u32 s39, s39, s42
    buffer_store_dwordx4 v[208:211], v236, s[64:67], s39 offen sc0 sc1
    s_lshl_b32 s39, s45, 6
    s_add_u32 s39, s39, s42
    buffer_store_dwordx4 v[212:215], v236, s[64:67], s39 offen sc0 sc1
    s_waitcnt vmcnt(10) lgkmcnt(0)
    s_branch g1_00_afterwait
g1_00_ev5:
    s_cmp_eq_u32 s31, 14
    s_cbranch_scc1 g1_00_ev14
    s_sub_u32 s39, s29, 1
    s_max_i32 s39, s39, 0
    s_lshl_b32 s39, s39, 2
    s_lshl_b32 s42, s76, 2
    s_add_u32 s42, s42, 32
    s_lshl_b32 s43, s29, 2
    v_mov_b32 v236, 0x1000
    v_writelane_b32 v236, s43, 0
    v_writelane_b32 v236, s42, 1
    s_cmp_lg_u32 s24, 0
    s_cselect_b32 s42, 0x1000, 0
    s_cmp_eq_u32 s31, 5
    s_cbranch_scc0 g1_00_ev12
    v_mov_b32 v237, 1
    buffer_atomic_add v237, v236, s[72:75], s42 offen sc1
    s_waitcnt vmcnt(9) lgkmcnt(0)
    s_branch g1_00_afterwait
g1_00_ev12:
    v_writelane_b32 v236, s39, 2
    s_nop 1
    buffer_load_dword v208, v236, s[72:75], s42 offen sc0 sc1
    s_waitcnt vmcnt(9) lgkmcnt(0)
    s_branch g1_00_afterwait
g1_00_ev14:
    s_cmp_eq_u32 s28, 0
    s_cbranch_scc0 g1_00_ev14b
    s_lshl_b32 s39, s29, 11
    s_sub_u32 s39, s39, 128
    v_add_u32 v236, s39, v216
    v_max_i32 v236, 0, v236
    s_add_u32 s39, s39, 1024
    v_add_u32 v237, s39, v216
    s_mov_b32 m0, 151552
    s_nop 0
    buffer_load_dwordx4 v236, s[64:67], 0 offen sc0 sc1 lds
    s_mov_b32 m0, 152576
    s_nop 0
    buffer_load_dwordx4 v237, s[64:67], 0 offen sc0 sc1 lds
    buffer_load_dwordx4 v237, s[64:67], 0 offen offset:1024 sc0 sc1 lds
    s_branch g1_00_ev14c
g1_00_ev14b:
    s_mul_i32 s39, s28, 3072
    s_sub_u32 s39, s39, 3072
    s_add_u32 m0, s39, 154624
    s_lshl_b32 s42, s76, 13
    s_add_u32 s42, s42, s39
    s_add_u32 s42, s42, 65536
    buffer_load_dwordx4 v216, s[64:67], s42 offen sc0 sc1 lds
    buffer_load_dwordx4 v216, s[64:67], s42 offen offset:1024 sc0 sc1 lds
    s_cmp_eq_u32 s28, 3
    s_cselect_b32 s39, 163840, m0
    s_mov_b32 m0, s39
    s_nop 0
    buffer_load_dwordx4 v216, s[64:67], s42 offen offset:2048 sc0 sc1 lds
g1_00_ev14c:
    s_mov_b32 s64, s92
    s_mov_b32 s65, s93
    s_mov_b32 s66, 2097152
    s_mov_b32 s72, s94
    s_mov_b32 s73, s95
    s_mov_b32 s74, 7340032
    s_mov_b32 s67, 0x20000
    s_mov_b32 s75, 0x20000
    s_lshl_b32 s39, s70, 2
    buffer_load_dwordx4 v[212:215], v216, s[64:67], s70 offen
    buffer_load_dwordx4 v[212:215], v216, s[72:75], s39 offen offset:0
    buffer_load_dwordx4 v[212:215], v216, s[72:75], s39 offen offset:1024
    buffer_load_dwordx4 v[212:215], v216, s[72:75], s39 offen offset:2048
    buffer_load_dwordx4 v[212:215], v216, s[72:75], s39 offen offset:3072
    s_waitcnt vmcnt(16) lgkmcnt(0)
    s_branch g1_00_afterwait
g1_00_post:
    v_mov_b32 v236, 0
    v_writelane_b32 v236, 32, 0
    v_writelane_b32 v236, 8, 1
    v_writelane_b32 v236, 32, 2
    s_nop 1
    v_cmp_ne_u32 vcc, v236, v208
    s_nop 3
    s_and_b32 s39, vcc_lo, 7
    v_mov_b32 v236, 163712
    v_mov_b32 v237, s39
    s_cmp_eq_u32 s24, 0
    s_cbranch_scc0 g1_00_red
    ds_write_b32 v236, v237
g1_00_red:
    s_lshl_b32 s39, s28, 8
    v_lshl_add_u32 v236, v250, 2, s39
    v_add_u32 v237, 154624, v236
    ds_read_b32 v112, v237 offset:0
    ds_read_b32 v113, v237 offset:1024
    ds_read_b32 v114, v237 offset:2048
    ds_read_b32 v115, v237 offset:3072
    ds_read_b32 v116, v237 offset:4096
    ds_read_b32 v117, v237 offset:5120
    ds_read_b32 v118, v237 offset:6144
    ds_read_b32 v119, v237 offset:7168
    v_min_u32 v236, 764, v236
    v_add_u32 v236, 162816, v236
    v_cmp_gt_u32 vcc, 155392, v237
    s_waitcnt lgkmcnt(0)
    v_add_f32 v112, v112, v113
    v_add_f32 v112, v112, v114
    v_add_f32 v112, v112, v115
    v_add_f32 v112, v112, v116
    v_add_f32 v112, v112, v117
    v_add_f32 v112, v112, v118
    v_add_f32 v112, v112, v119
    s_and_saveexec_b64 s[42:43], vcc
    ds_write_b32 v236, v112
    s_mov_b64 exec, -1
    s_waitcnt lgkmcnt(0)
    s_barrier
    v_mov_b32 v236, 163712
    ds_read_b32 v237, v236
    s_waitcnt lgkmcnt(0)
    v_readfirstlane_b32 s39, v237
    s_nop 3
    s_cmp_eq_u32 s39, 0
    s_cbranch_scc1 g1_00_fast
    s_barrier
    s_mov_b32 s14, 4194304
    s_mov_b32 s18, 6291456
    s_mov_b32 s31, s24
g1_00_slow1:
    s_lshl_b32 s39, s29, 8
    s_add_u32 s39, s39, s31
    s_sub_u32 s39, s39, 16
    s_max_i32 s39, s39, 0
    s_lshl_b32 s39, s39, 11
    buffer_load_dwordx4 v[112:115], v216, s[12:15], s39 offen
    buffer_load_dwordx4 v[116:119], v216, s[12:15], s39 offen offset:1024
    s_waitcnt vmcnt(0)
    v_lshlrev_b32 v144, 16, v112
    v_and_b32 v145, 0xffff0000, v112
    v_lshlrev_b32 v146, 16, v113
    v_and_b32 v147, 0xffff0000, v113
    v_lshlrev_b32 v148, 16, v114
    v_and_b32 v149, 0xffff0000, v114
    v_lshlrev_b32 v150, 16, v115
    v_and_b32 v151, 0xffff0000, v115
    v_lshlrev_b32 v152, 16, v116
    v_and_b32 v153, 0xffff0000, v116
    v_lshlrev_b32 v154, 16, v117
    v_and_b32 v155, 0xffff0000, v117
    v_lshlrev_b32 v156, 16, v118
    v_and_b32 v157, 0xffff0000, v118
    v_lshlrev_b32 v158, 16, v119
    v_and_b32 v159, 0xffff0000, v119
    v_pk_add_f32 v[160:161], v[144:145], v[146:147]
    v_pk_add_f32 v[160:161], v[160:161], v[148:149]
    v_pk_add_f32 v[160:161], v[160:161], v[150:151]
    v_pk_add_f32 v[160:161], v[160:161], v[152:153]
    v_pk_add_f32 v[160:161], v[160:161], v[154:155]
    v_pk_add_f32 v[160:161], v[160:161], v[156:157]
    v_pk_add_f32 v[160:161], v[160:161], v[158:159]
    v_add_f32 v164, v160, v161
    s_nop 1
    v_add_f32_dpp v165, v164, v164 quad_perm:[1,0,3,2] row_mask:0xf bank_mask:0xf
    s_nop 1
    v_add_f32_dpp v164, v165, v165 quad_perm:[2,3,0,1] row_mask:0xf bank_mask:0xf
    s_nop 1
    v_add_f32_dpp v165, v164, v164 row_half_mirror row_mask:0xf bank_mask:0xf
    s_nop 1
    v_add_f32_dpp v164, v165, v165 row_mirror row_mask:0xf bank_mask:0xf
    v_mov_b32 v165, v164
    s_nop 1
    v_permlane16_swap_b32 v164, v165
    s_nop 1
    v_add_f32 v164, v164, v165
    v_mov_b32 v165, v164
    s_nop 1
    v_permlane32_swap_b32 v164, v165
    s_nop 1
    v_add_f32 v164, v164, v165
    v_mul_f32 v164, 0x3a800000, v164
    v_pk_add_f32 v[144:145], v[144:145], v[164:165] op_sel_hi:[1,0] neg_lo:[0,1] neg_hi:[0,1]
    v_pk_add_f32 v[146:147], v[146:147], v[164:165] op_sel_hi:[1,0] neg_lo:[0,1] neg_hi:[0,1]
    v_pk_add_f32 v[148:149], v[148:149], v[164:165] op_sel_hi:[1,0] neg_lo:[0,1] neg_hi:[0,1]
    v_pk_add_f32 v[150:151], v[150:151], v[164:165] op_sel_hi:[1,0] neg_lo:[0,1] neg_hi:[0,1]
    v_pk_add_f32 v[152:153], v[152:153], v[164:165] op_sel_hi:[1,0] neg_lo:[0,1] neg_hi:[0,1]
    v_pk_add_f32 v[154:155], v[154:155], v[164:165] op_sel_hi:[1,0] neg_lo:[0,1] neg_hi:[0,1]
    v_pk_add_f32 v[156:157], v[156:157], v[164:165] op_sel_hi:[1,0] neg_lo:[0,1] neg_hi:[0,1]
    v_pk_add_f32 v[158:159], v[158:159], v[164:165] op_sel_hi:[1,0] neg_lo:[0,1] neg_hi:[0,1]
    v_pk_mul_f32 v[160:161], v[144:145], v[144:145]
    v_pk_fma_f32 v[160:161], v[146:147], v[146:147], v[160:161]
    v_pk_fma_f32 v[160:161], v[148:149], v[148:149], v[160:161]
    v_pk_fma_f32 v[160:161], v[150:151], v[150:151], v[160:161]
    v_pk_fma_f32 v[160:161], v[152:153], v[152:153], v[160:161]
    v_pk_fma_f32 v[160:161], v[154:155], v[154:155], v[160:161]
    v_pk_fma_f32 v[160:161], v[156:157], v[156:157], v[160:161]
    v_pk_fma_f32 v[160:161], v[158:159], v[158:159], v[160:161]
    v_add_f32 v161, v160, v161
    s_nop 1
    v_add_f32_dpp v165, v161, v161 quad_perm:[1,0,3,2] row_mask:0xf bank_mask:0xf
    s_nop 1
    v_add_f32_dpp v161, v165, v165 quad_perm:[2,3,0,1] row_mask:0xf bank_mask:0xf
    s_nop 1
    v_add_f32_dpp v165, v161, v161 row_half_mirror row_mask:0xf bank_mask:0xf
    s_nop 1
    v_add_f32_dpp v161, v165, v165 row_mirror row_mask:0xf bank_mask:0xf
    v_mov_b32 v165, v161
    s_nop 1
    v_permlane16_swap_b32 v161, v165
    s_nop 1
    v_add_f32 v161, v161, v165
    v_mov_b32 v165, v161
    s_nop 1
    v_permlane32_swap_b32 v161, v165
    s_nop 1
    v_add_f32 v161, v161, v165
    v_mul_f32 v161, 0x3a800000, v161
    v_cvt_pk_bf16_f32 v165, v164, v161
    v_lshlrev_b32 v160, 16, v165
    v_and_b32 v161, 0xffff0000, v165
    v_add_f32 v161, 0x3727c5ac, v161
    v_cvt_pk_bf16_f32 v161, v161, v161
    v_and_b32 v161, 0xffff0000, v161
    v_sqrt_f32 v161, v161
    s_nop 0
    v_cvt_pk_bf16_f32 v161, v161, v161
    v_and_b32 v161, 0xffff0000, v161
    v_rcp_f32 v161, v161
    s_nop 0
    s_lshl_b32 s39, s31, 3
    s_add_u32 s39, s39, 151552
    v_mov_b32 v236, s39
    ds_write_b64 v236, v[160:161]
    s_add_u32 s31, s31, 8
    s_cmp_lt_u32 s31, 272
    s_cbranch_scc1 g1_00_slow1
    v_min_u32 v236, 23, v250
    v_cmp_le_u32 vcc, 12, v236
    s_nop 1
    v_cndmask_b32 v237, 0, 1, vcc
    v_mul_u32_u24 v238, 12, v237
    v_sub_u32 v238, v236, v238
    v_lshrrev_b32 v239, 2, v238
    v_and_b32 v238, 3, v238
    v_lshlrev_b32 v239, 11, v239
    v_lshl_add_u32 v239, v237, 6, v239
    v_lshl_add_u32 v239, v238, 4, v239
    s_lshl_b32 s39, s30, 7
    v_add_u32 v239, s39, v239
    v_mov_b32 v144, 0
    v_mov_b32 v145, 0
    v_mov_b32 v146, 0
    v_mov_b32 v147, 0
    v_mov_b32 v148, 0
    v_mov_b32 v149, 0
    v_mov_b32 v150, 0
    v_mov_b32 v151, 0
    s_mul_i32 s39, s24, 786432
    s_mov_b32 s31, 0
g1_00_slow2:
    buffer_load_dwordx4 v[112:115], v239, s[16:19], s39 offen
    s_add_u32 s39, s39, 6144
    s_add_u32 s31, s31, 1
    s_waitcnt vmcnt(0)
    v_lshlrev_b32 v116, 16, v112
    v_and_b32 v117, 0xffff0000, v112
    v_pk_add_f32 v[144:145], v[144:145], v[116:117]
    v_lshlrev_b32 v116, 16, v113
    v_and_b32 v117, 0xffff0000, v113
    v_pk_add_f32 v[146:147], v[146:147], v[116:117]
    v_lshlrev_b32 v116, 16, v114
    v_and_b32 v117, 0xffff0000, v114
    v_pk_add_f32 v[148:149], v[148:149], v[116:117]
    v_lshlrev_b32 v116, 16, v115
    v_and_b32 v117, 0xffff0000, v115
    v_pk_add_f32 v[150:151], v[150:151], v[116:117]
    s_cmp_lt_u32 s31, 128
    s_cbranch_scc1 g1_00_slow2
    s_lshl_b32 s39, s24, 10
    s_add_u32 s39, s39, 154624
    v_lshl_add_u32 v236, v236, 5, s39
    ds_write_b128 v236, v[144:147]
    ds_write_b128 v236, v[148:151] offset:16
    v_mov_b32 v236, 163712
    v_mov_b32 v237, 0
    ds_write_b32 v236, v237
    s_waitcnt lgkmcnt(0)
    s_barrier
    s_branch g1_00_red
g1_00_fast:
    s_lshl_b32 s39, s26, 6
    s_lshl_b32 s42, s27, 5
    s_xor_b32 s42, s42, 0
    s_add_u32 s39, s39, s42
    s_add_u32 s52, s39, 0
    s_lshl_b32 s39, s26, 6
    s_lshl_b32 s42, s27, 5
    s_xor_b32 s42, s42, 16
    s_add_u32 s39, s39, s42
    s_add_u32 s53, s39, 0
    s_lshl_b32 s39, s26, 6
    s_lshl_b32 s42, s27, 5
    s_xor_b32 s42, s42, 32
    s_add_u32 s39, s39, s42
    s_add_u32 s54, s39, 0
    s_lshl_b32 s39, s26, 6
    s_lshl_b32 s42, s27, 5
    s_xor_b32 s42, s42, 48
    s_add_u32 s39, s39, s42
    s_add_u32 s55, s39, 0
    s_add_u32 s39, s52, 18960
    v_add_u32 v240, s39, v251
    v_lshlrev_b32 v240, 3, v240
    ds_read_b64 v[112:113], v240
    s_add_u32 s39, s53, 18960
    v_add_u32 v240, s39, v251
    v_lshlrev_b32 v240, 3, v240
    ds_read_b64 v[114:115], v240
    s_add_u32 s39, s54, 18960
    v_add_u32 v240, s39, v251
    v_lshlrev_b32 v240, 3, v240
    ds_read_b64 v[116:117], v240
    s_add_u32 s39, s55, 18960
    v_add_u32 v240, s39, v251
    v_lshlrev_b32 v240, 3, v240
    ds_read_b64 v[118:119], v240
    v_lshlrev_b32 v240, 3, v251
    v_add_u32 v240, 151552, v240
    ds_read_b64 v[120:121], v240
    s_lshl_b32 s39, s44, 6
    s_add_u32 s39, s39, 162816
    v_lshl_add_u32 v240, v252, 4, s39
    ds_read_b128 v[144:147], v240
    s_lshl_b32 s39, s45, 6
    s_add_u32 s39, s39, 162816
    v_lshl_add_u32 v240, v252, 4, s39
    ds_read_b128 v[148:151], v240
    s_lshl_b32 s39, s46, 6
    s_add_u32 s39, s39, 162816
    v_lshl_add_u32 v240, v252, 4, s39
    ds_read_b128 v[152:155], v240
    s_lshl_b32 s39, s47, 6
    s_add_u32 s39, s39, 162816
    v_lshl_add_u32 v240, v252, 4, s39
    ds_read_b128 v[156:159], v240
    s_lshl_b32 s39, s48, 6
    s_add_u32 s39, s39, 162816
    v_lshl_add_u32 v240, v252, 4, s39
    ds_read_b128 v[160:163], v240
    s_lshl_b32 s39, s49, 6
    s_add_u32 s39, s39, 162816
    v_lshl_add_u32 v240, v252, 4, s39
    ds_read_b128 v[164:167], v240
    s_waitcnt lgkmcnt(0)
    v_and_b32 v236, 1, v252
    v_lshrrev_b32 v237, 1, v252
    v_lshl_or_b32 v244, v236, 1, v237
    v_mul_u32_u24 v245, 400, v251
    v_lshl_add_u32 v245, v252, 3, v245
    s_add_u32 s39, s52, 16
    s_mul_i32 s43, s39, 400
    v_pk_fma_f32 v[0:1], v[144:145], v[112:113], v[0:1] op_sel_hi:[1,0,1] neg_lo:[0,1,0] neg_hi:[0,1,0]
    v_pk_fma_f32 v[2:3], v[146:147], v[112:113], v[2:3] op_sel_hi:[1,0,1] neg_lo:[0,1,0] neg_hi:[0,1,0]
    v_pk_mul_f32 v[0:1], v[0:1], v[112:113] op_sel:[0,1] op_sel_hi:[1,1]
    v_pk_mul_f32 v[2:3], v[2:3], v[112:113] op_sel:[0,1] op_sel_hi:[1,1]
    v_cvt_pk_bf16_f32 v128, v0, v1
    v_cvt_pk_bf16_f32 v129, v2, v3
    s_lshl_b32 s39, s44, 5
    s_add_u32 s39, s39, s43
    v_add_u32 v236, s39, v245
    ds_write_b64 v236, v[128:129]
    v_pk_fma_f32 v[16:17], v[148:149], v[112:113], v[16:17] op_sel_hi:[1,0,1] neg_lo:[0,1,0] neg_hi:[0,1,0]
    v_pk_fma_f32 v[18:19], v[150:151], v[112:113], v[18:19] op_sel_hi:[1,0,1] neg_lo:[0,1,0] neg_hi:[0,1,0]
    v_pk_mul_f32 v[16:17], v[16:17], v[112:113] op_sel:[0,1] op_sel_hi:[1,1]
    v_pk_mul_f32 v[18:19], v[18:19], v[112:113] op_sel:[0,1] op_sel_hi:[1,1]
    v_cvt_pk_bf16_f32 v130, v16, v17
    v_cvt_pk_bf16_f32 v131, v18, v19
    s_lshl_b32 s39, s45, 5
    s_add_u32 s39, s39, s43
    v_add_u32 v236, s39, v245
    ds_write_b64 v236, v[130:131]
    v_pk_fma_f32 v[32:33], v[152:153], v[112:113], v[32:33] op_sel_hi:[1,0,1] neg_lo:[0,1,0] neg_hi:[0,1,0]
    v_pk_fma_f32 v[34:35], v[154:155], v[112:113], v[34:35] op_sel_hi:[1,0,1] neg_lo:[0,1,0] neg_hi:[0,1,0]
    v_pk_mul_f32 v[32:33], v[32:33], v[112:113] op_sel:[0,1] op_sel_hi:[1,1]
    v_pk_mul_f32 v[34:35], v[34:35], v[112:113] op_sel:[0,1] op_sel_hi:[1,1]
    v_cvt_pk_bf16_f32 v132, v32, v33
    v_cvt_pk_bf16_f32 v133, v34, v35
    s_lshl_b32 s39, s46, 5
    s_add_u32 s39, s39, s43
    v_add_u32 v236, s39, v245
    ds_write_b64 v236, v[132:133]
    v_pk_fma_f32 v[48:49], v[156:157], v[112:113], v[48:49] op_sel_hi:[1,0,1] neg_lo:[0,1,0] neg_hi:[0,1,0]
    v_pk_fma_f32 v[50:51], v[158:159], v[112:113], v[50:51] op_sel_hi:[1,0,1] neg_lo:[0,1,0] neg_hi:[0,1,0]
    v_pk_mul_f32 v[48:49], v[48:49], v[112:113] op_sel:[0,1] op_sel_hi:[1,1]
    v_pk_mul_f32 v[50:51], v[50:51], v[112:113] op_sel:[0,1] op_sel_hi:[1,1]
    v_cvt_pk_bf16_f32 v134, v48, v49
    v_cvt_pk_bf16_f32 v135, v50, v51
    s_lshl_b32 s39, s47, 5
    s_add_u32 s39, s39, s43
    v_add_u32 v236, s39, v245
    ds_write_b64 v236, v[134:135]
    v_pk_fma_f32 v[64:65], v[160:161], v[112:113], v[64:65] op_sel_hi:[1,0,1] neg_lo:[0,1,0] neg_hi:[0,1,0]
    v_pk_fma_f32 v[66:67], v[162:163], v[112:113], v[66:67] op_sel_hi:[1,0,1] neg_lo:[0,1,0] neg_hi:[0,1,0]
    v_pk_mul_f32 v[64:65], v[64:65], v[112:113] op_sel:[0,1] op_sel_hi:[1,1]
    v_pk_mul_f32 v[66:67], v[66:67], v[112:113] op_sel:[0,1] op_sel_hi:[1,1]
    v_cvt_pk_bf16_f32 v136, v64, v65
    v_cvt_pk_bf16_f32 v137, v66, v67
    s_lshl_b32 s39, s48, 5
    s_add_u32 s39, s39, s43
    v_add_u32 v236, s39, v245
    ds_write_b64 v236, v[136:137]
    v_pk_fma_f32 v[80:81], v[164:165], v[112:113], v[80:81] op_sel_hi:[1,0,1] neg_lo:[0,1,0] neg_hi:[0,1,0]
    v_pk_fma_f32 v[82:83], v[166:167], v[112:113], v[82:83] op_sel_hi:[1,0,1] neg_lo:[0,1,0] neg_hi:[0,1,0]
    v_pk_mul_f32 v[80:81], v[80:81], v[112:113] op_sel:[0,1] op_sel_hi:[1,1]
    v_pk_mul_f32 v[82:83], v[82:83], v[112:113] op_sel:[0,1] op_sel_hi:[1,1]
    v_cvt_pk_bf16_f32 v138, v80, v81
    v_cvt_pk_bf16_f32 v139, v82, v83
    s_lshl_b32 s39, s49, 5
    s_add_u32 s39, s39, s43
    v_add_u32 v236, s39, v245
    ds_write_b64 v236, v[138:139]
    s_add_u32 s39, s53, 16
    s_mul_i32 s43, s39, 400
    v_pk_fma_f32 v[4:5], v[144:145], v[114:115], v[4:5] op_sel_hi:[1,0,1] neg_lo:[0,1,0] neg_hi:[0,1,0]
    v_pk_fma_f32 v[6:7], v[146:147], v[114:115], v[6:7] op_sel_hi:[1,0,1] neg_lo:[0,1,0] neg_hi:[0,1,0]
    v_pk_mul_f32 v[4:5], v[4:5], v[114:115] op_sel:[0,1] op_sel_hi:[1,1]
    v_pk_mul_f32 v[6:7], v[6:7], v[114:115] op_sel:[0,1] op_sel_hi:[1,1]
    v_cvt_pk_bf16_f32 v140, v4, v5
    v_cvt_pk_bf16_f32 v141, v6, v7
    s_lshl_b32 s39, s44, 5
    s_add_u32 s39, s39, s43
    v_add_u32 v236, s39, v245
    ds_write_b64 v236, v[140:141]
    v_pk_fma_f32 v[20:21], v[148:149], v[114:115], v[20:21] op_sel_hi:[1,0,1] neg_lo:[0,1,0] neg_hi:[0,1,0]
    v_pk_fma_f32 v[22:23], v[150:151], v[114:115], v[22:23] op_sel_hi:[1,0,1] neg_lo:[0,1,0] neg_hi:[0,1,0]
    v_pk_mul_f32 v[20:21], v[20:21], v[114:115] op_sel:[0,1] op_sel_hi:[1,1]
    v_pk_mul_f32 v[22:23], v[22:23], v[114:115] op_sel:[0,1] op_sel_hi:[1,1]
    v_cvt_pk_bf16_f32 v142, v20, v21
    v_cvt_pk_bf16_f32 v143, v22, v23
    s_lshl_b32 s39, s45, 5
    s_add_u32 s39, s39, s43
    v_add_u32 v236, s39, v245
    ds_write_b64 v236, v[142:143]
    v_pk_fma_f32 v[36:37], v[152:153], v[114:115], v[36:37] op_sel_hi:[1,0,1] neg_lo:[0,1,0] neg_hi:[0,1,0]
    v_pk_fma_f32 v[38:39], v[154:155], v[114:115], v[38:39] op_sel_hi:[1,0,1] neg_lo:[0,1,0] neg_hi:[0,1,0]
    v_pk_mul_f32 v[36:37], v[36:37], v[114:115] op_sel:[0,1] op_sel_hi:[1,1]
    v_pk_mul_f32 v[38:39], v[38:39], v[114:115] op_sel:[0,1] op_sel_hi:[1,1]
    v_cvt_pk_bf16_f32 v128, v36, v37
    v_cvt_pk_bf16_f32 v129, v38, v39
    s_lshl_b32 s39, s46, 5
    s_add_u32 s39, s39, s43
    v_add_u32 v236, s39, v245
    ds_write_b64 v236, v[128:129]
    v_pk_fma_f32 v[52:53], v[156:157], v[114:115], v[52:53] op_sel_hi:[1,0,1] neg_lo:[0,1,0] neg_hi:[0,1,0]
    v_pk_fma_f32 v[54:55], v[158:159], v[114:115], v[54:55] op_sel_hi:[1,0,1] neg_lo:[0,1,0] neg_hi:[0,1,0]
    v_pk_mul_f32 v[52:53], v[52:53], v[114:115] op_sel:[0,1] op_sel_hi:[1,1]
    v_pk_mul_f32 v[54:55], v[54:55], v[114:115] op_sel:[0,1] op_sel_hi:[1,1]
    v_cvt_pk_bf16_f32 v130, v52, v53
    v_cvt_pk_bf16_f32 v131, v54, v55
    s_lshl_b32 s39, s47, 5
    s_add_u32 s39, s39, s43
    v_add_u32 v236, s39, v245
    ds_write_b64 v236, v[130:131]
    v_pk_fma_f32 v[68:69], v[160:161], v[114:115], v[68:69] op_sel_hi:[1,0,1] neg_lo:[0,1,0] neg_hi:[0,1,0]
    v_pk_fma_f32 v[70:71], v[162:163], v[114:115], v[70:71] op_sel_hi:[1,0,1] neg_lo:[0,1,0] neg_hi:[0,1,0]
    v_pk_mul_f32 v[68:69], v[68:69], v[114:115] op_sel:[0,1] op_sel_hi:[1,1]
    v_pk_mul_f32 v[70:71], v[70:71], v[114:115] op_sel:[0,1] op_sel_hi:[1,1]
    v_cvt_pk_bf16_f32 v132, v68, v69
    v_cvt_pk_bf16_f32 v133, v70, v71
    s_lshl_b32 s39, s48, 5
    s_add_u32 s39, s39, s43
    v_add_u32 v236, s39, v245
    ds_write_b64 v236, v[132:133]
    v_pk_fma_f32 v[84:85], v[164:165], v[114:115], v[84:85] op_sel_hi:[1,0,1] neg_lo:[0,1,0] neg_hi:[0,1,0]
    v_pk_fma_f32 v[86:87], v[166:167], v[114:115], v[86:87] op_sel_hi:[1,0,1] neg_lo:[0,1,0] neg_hi:[0,1,0]
    v_pk_mul_f32 v[84:85], v[84:85], v[114:115] op_sel:[0,1] op_sel_hi:[1,1]
    v_pk_mul_f32 v[86:87], v[86:87], v[114:115] op_sel:[0,1] op_sel_hi:[1,1]
    v_cvt_pk_bf16_f32 v134, v84, v85
    v_cvt_pk_bf16_f32 v135, v86, v87
    s_lshl_b32 s39, s49, 5
    s_add_u32 s39, s39, s43
    v_add_u32 v236, s39, v245
    ds_write_b64 v236, v[134:135]
    s_add_u32 s39, s54, 16
    s_mul_i32 s43, s39, 400
    v_pk_fma_f32 v[8:9], v[144:145], v[116:117], v[8:9] op_sel_hi:[1,0,1] neg_lo:[0,1,0] neg_hi:[0,1,0]
    v_pk_fma_f32 v[10:11], v[146:147], v[116:117], v[10:11] op_sel_hi:[1,0,1] neg_lo:[0,1,0] neg_hi:[0,1,0]
    v_pk_mul_f32 v[8:9], v[8:9], v[116:117] op_sel:[0,1] op_sel_hi:[1,1]
    v_pk_mul_f32 v[10:11], v[10:11], v[116:117] op_sel:[0,1] op_sel_hi:[1,1]
    v_cvt_pk_bf16_f32 v136, v8, v9
    v_cvt_pk_bf16_f32 v137, v10, v11
    s_lshl_b32 s39, s44, 5
    s_add_u32 s39, s39, s43
    v_add_u32 v236, s39, v245
    ds_write_b64 v236, v[136:137]
    v_pk_fma_f32 v[24:25], v[148:149], v[116:117], v[24:25] op_sel_hi:[1,0,1] neg_lo:[0,1,0] neg_hi:[0,1,0]
    v_pk_fma_f32 v[26:27], v[150:151], v[116:117], v[26:27] op_sel_hi:[1,0,1] neg_lo:[0,1,0] neg_hi:[0,1,0]
    v_pk_mul_f32 v[24:25], v[24:25], v[116:117] op_sel:[0,1] op_sel_hi:[1,1]
    v_pk_mul_f32 v[26:27], v[26:27], v[116:117] op_sel:[0,1] op_sel_hi:[1,1]
    v_cvt_pk_bf16_f32 v138, v24, v25
    v_cvt_pk_bf16_f32 v139, v26, v27
    s_lshl_b32 s39, s45, 5
    s_add_u32 s39, s39, s43
    v_add_u32 v236, s39, v245
    ds_write_b64 v236, v[138:139]
    v_pk_fma_f32 v[40:41], v[152:153], v[116:117], v[40:41] op_sel_hi:[1,0,1] neg_lo:[0,1,0] neg_hi:[0,1,0]
    v_pk_fma_f32 v[42:43], v[154:155], v[116:117], v[42:43] op_sel_hi:[1,0,1] neg_lo:[0,1,0] neg_hi:[0,1,0]
    v_pk_mul_f32 v[40:41], v[40:41], v[116:117] op_sel:[0,1] op_sel_hi:[1,1]
    v_pk_mul_f32 v[42:43], v[42:43], v[116:117] op_sel:[0,1] op_sel_hi:[1,1]
    v_cvt_pk_bf16_f32 v140, v40, v41
    v_cvt_pk_bf16_f32 v141, v42, v43
    s_lshl_b32 s39, s46, 5
    s_add_u32 s39, s39, s43
    v_add_u32 v236, s39, v245
    ds_write_b64 v236, v[140:141]
    v_pk_fma_f32 v[56:57], v[156:157], v[116:117], v[56:57] op_sel_hi:[1,0,1] neg_lo:[0,1,0] neg_hi:[0,1,0]
    v_pk_fma_f32 v[58:59], v[158:159], v[116:117], v[58:59] op_sel_hi:[1,0,1] neg_lo:[0,1,0] neg_hi:[0,1,0]
    v_pk_mul_f32 v[56:57], v[56:57], v[116:117] op_sel:[0,1] op_sel_hi:[1,1]
    v_pk_mul_f32 v[58:59], v[58:59], v[116:117] op_sel:[0,1] op_sel_hi:[1,1]
    v_cvt_pk_bf16_f32 v142, v56, v57
    v_cvt_pk_bf16_f32 v143, v58, v59
    s_lshl_b32 s39, s47, 5
    s_add_u32 s39, s39, s43
    v_add_u32 v236, s39, v245
    ds_write_b64 v236, v[142:143]
    v_pk_fma_f32 v[72:73], v[160:161], v[116:117], v[72:73] op_sel_hi:[1,0,1] neg_lo:[0,1,0] neg_hi:[0,1,0]
    v_pk_fma_f32 v[74:75], v[162:163], v[116:117], v[74:75] op_sel_hi:[1,0,1] neg_lo:[0,1,0] neg_hi:[0,1,0]
    v_pk_mul_f32 v[72:73], v[72:73], v[116:117] op_sel:[0,1] op_sel_hi:[1,1]
    v_pk_mul_f32 v[74:75], v[74:75], v[116:117] op_sel:[0,1] op_sel_hi:[1,1]
    v_cvt_pk_bf16_f32 v128, v72, v73
    v_cvt_pk_bf16_f32 v129, v74, v75
    s_lshl_b32 s39, s48, 5
    s_add_u32 s39, s39, s43
    v_add_u32 v236, s39, v245
    ds_write_b64 v236, v[128:129]
    v_pk_fma_f32 v[88:89], v[164:165], v[116:117], v[88:89] op_sel_hi:[1,0,1] neg_lo:[0,1,0] neg_hi:[0,1,0]
    v_pk_fma_f32 v[90:91], v[166:167], v[116:117], v[90:91] op_sel_hi:[1,0,1] neg_lo:[0,1,0] neg_hi:[0,1,0]
    v_pk_mul_f32 v[88:89], v[88:89], v[116:117] op_sel:[0,1] op_sel_hi:[1,1]
    v_pk_mul_f32 v[90:91], v[90:91], v[116:117] op_sel:[0,1] op_sel_hi:[1,1]
    v_cvt_pk_bf16_f32 v130, v88, v89
    v_cvt_pk_bf16_f32 v131, v90, v91
    s_lshl_b32 s39, s49, 5
    s_add_u32 s39, s39, s43
    v_add_u32 v236, s39, v245
    ds_write_b64 v236, v[130:131]
    s_add_u32 s39, s55, 16
    s_mul_i32 s43, s39, 400
    v_pk_fma_f32 v[12:13], v[144:145], v[118:119], v[12:13] op_sel_hi:[1,0,1] neg_lo:[0,1,0] neg_hi:[0,1,0]
    v_pk_fma_f32 v[14:15], v[146:147], v[118:119], v[14:15] op_sel_hi:[1,0,1] neg_lo:[0,1,0] neg_hi:[0,1,0]
    v_pk_mul_f32 v[12:13], v[12:13], v[118:119] op_sel:[0,1] op_sel_hi:[1,1]
    v_pk_mul_f32 v[14:15], v[14:15], v[118:119] op_sel:[0,1] op_sel_hi:[1,1]
    v_cvt_pk_bf16_f32 v132, v12, v13
    v_cvt_pk_bf16_f32 v133, v14, v15
    s_lshl_b32 s39, s44, 5
    s_add_u32 s39, s39, s43
    v_add_u32 v236, s39, v245
    ds_write_b64 v236, v[132:133]
    v_pk_fma_f32 v[28:29], v[148:149], v[118:119], v[28:29] op_sel_hi:[1,0,1] neg_lo:[0,1,0] neg_hi:[0,1,0]
    v_pk_fma_f32 v[30:31], v[150:151], v[118:119], v[30:31] op_sel_hi:[1,0,1] neg_lo:[0,1,0] neg_hi:[0,1,0]
    v_pk_mul_f32 v[28:29], v[28:29], v[118:119] op_sel:[0,1] op_sel_hi:[1,1]
    v_pk_mul_f32 v[30:31], v[30:31], v[118:119] op_sel:[0,1] op_sel_hi:[1,1]
    v_cvt_pk_bf16_f32 v134, v28, v29
    v_cvt_pk_bf16_f32 v135, v30, v31
    s_lshl_b32 s39, s45, 5
    s_add_u32 s39, s39, s43
    v_add_u32 v236, s39, v245
    ds_write_b64 v236, v[134:135]
    v_pk_fma_f32 v[44:45], v[152:153], v[118:119], v[44:45] op_sel_hi:[1,0,1] neg_lo:[0,1,0] neg_hi:[0,1,0]
    v_pk_fma_f32 v[46:47], v[154:155], v[118:119], v[46:47] op_sel_hi:[1,0,1] neg_lo:[0,1,0] neg_hi:[0,1,0]
    v_pk_mul_f32 v[44:45], v[44:45], v[118:119] op_sel:[0,1] op_sel_hi:[1,1]
    v_pk_mul_f32 v[46:47], v[46:47], v[118:119] op_sel:[0,1] op_sel_hi:[1,1]
    v_cvt_pk_bf16_f32 v136, v44, v45
    v_cvt_pk_bf16_f32 v137, v46, v47
    s_lshl_b32 s39, s46, 5
    s_add_u32 s39, s39, s43
    v_add_u32 v236, s39, v245
    ds_write_b64 v236, v[136:137]
    v_pk_fma_f32 v[60:61], v[156:157], v[118:119], v[60:61] op_sel_hi:[1,0,1] neg_lo:[0,1,0] neg_hi:[0,1,0]
    v_pk_fma_f32 v[62:63], v[158:159], v[118:119], v[62:63] op_sel_hi:[1,0,1] neg_lo:[0,1,0] neg_hi:[0,1,0]
    v_pk_mul_f32 v[60:61], v[60:61], v[118:119] op_sel:[0,1] op_sel_hi:[1,1]
    v_pk_mul_f32 v[62:63], v[62:63], v[118:119] op_sel:[0,1] op_sel_hi:[1,1]
    v_cvt_pk_bf16_f32 v138, v60, v61
    v_cvt_pk_bf16_f32 v139, v62, v63
    s_lshl_b32 s39, s47, 5
    s_add_u32 s39, s39, s43
    v_add_u32 v236, s39, v245
    ds_write_b64 v236, v[138:139]
    v_pk_fma_f32 v[76:77], v[160:161], v[118:119], v[76:77] op_sel_hi:[1,0,1] neg_lo:[0,1,0] neg_hi:[0,1,0]
    v_pk_fma_f32 v[78:79], v[162:163], v[118:119], v[78:79] op_sel_hi:[1,0,1] neg_lo:[0,1,0] neg_hi:[0,1,0]
    v_pk_mul_f32 v[76:77], v[76:77], v[118:119] op_sel:[0,1] op_sel_hi:[1,1]
    v_pk_mul_f32 v[78:79], v[78:79], v[118:119] op_sel:[0,1] op_sel_hi:[1,1]
    v_cvt_pk_bf16_f32 v140, v76, v77
    v_cvt_pk_bf16_f32 v141, v78, v79
    s_lshl_b32 s39, s48, 5
    s_add_u32 s39, s39, s43
    v_add_u32 v236, s39, v245
    ds_write_b64 v236, v[140:141]
    v_pk_fma_f32 v[92:93], v[164:165], v[118:119], v[92:93] op_sel_hi:[1,0,1] neg_lo:[0,1,0] neg_hi:[0,1,0]
    v_pk_fma_f32 v[94:95], v[166:167], v[118:119], v[94:95] op_sel_hi:[1,0,1] neg_lo:[0,1,0] neg_hi:[0,1,0]
    v_pk_mul_f32 v[92:93], v[92:93], v[118:119] op_sel:[0,1] op_sel_hi:[1,1]
    v_pk_mul_f32 v[94:95], v[94:95], v[118:119] op_sel:[0,1] op_sel_hi:[1,1]
    v_cvt_pk_bf16_f32 v142, v92, v93
    v_cvt_pk_bf16_f32 v143, v94, v95
    s_lshl_b32 s39, s49, 5
    s_add_u32 s39, s39, s43
    v_add_u32 v236, s39, v245
    ds_write_b64 v236, v[142:143]
    v_pk_fma_f32 v[96:97], v[144:145], v[120:121], v[96:97] op_sel_hi:[1,0,1] neg_lo:[0,1,0] neg_hi:[0,1,0]
    v_pk_fma_f32 v[98:99], v[146:147], v[120:121], v[98:99] op_sel_hi:[1,0,1] neg_lo:[0,1,0] neg_hi:[0,1,0]
    v_pk_mul_f32 v[96:97], v[96:97], v[120:121] op_sel:[0,1] op_sel_hi:[1,1]
    v_pk_mul_f32 v[98:99], v[98:99], v[120:121] op_sel:[0,1] op_sel_hi:[1,1]
    v_cvt_pk_bf16_f32 v128, v96, v97
    v_cvt_pk_bf16_f32 v129, v98, v99
    s_lshl_b32 s39, s44, 5
    v_add_u32 v236, s39, v245
    ds_write_b64 v236, v[128:129]
    v_pk_fma_f32 v[100:101], v[148:149], v[120:121], v[100:101] op_sel_hi:[1,0,1] neg_lo:[0,1,0] neg_hi:[0,1,0]
    v_pk_fma_f32 v[102:103], v[150:151], v[120:121], v[102:103] op_sel_hi:[1,0,1] neg_lo:[0,1,0] neg_hi:[0,1,0]
    v_pk_mul_f32 v[100:101], v[100:101], v[120:121] op_sel:[0,1] op_sel_hi:[1,1]
    v_pk_mul_f32 v[102:103], v[102:103], v[120:121] op_sel:[0,1] op_sel_hi:[1,1]
    v_cvt_pk_bf16_f32 v130, v100, v101
    v_cvt_pk_bf16_f32 v131, v102, v103
    s_lshl_b32 s39, s45, 5
    v_add_u32 v236, s39, v245
    ds_write_b64 v236, v[130:131]
    s_waitcnt lgkmcnt(0)
    s_barrier
    s_branch g1_attn
g1_01:
    s_mov_b32 s16, s6
    s_and_b32 s17, s7, 0xffff
    s_mov_b32 s18, 6291456
    s_mov_b32 s19, 0x20000
    v_lshrrev_b32 v236, 3, v250
    v_and_b32 v237, 7, v250
    v_xor_b32 v237, v237, v236
    s_lshl_b32 s39, s29, 8
    s_lshl_b32 s42, s28, 5
    s_add_u32 s39, s39, s42
    s_add_u32 s39, s39, 0
    v_add_u32 v238, s39, v236
    v_lshlrev_b32 v238, 11, v238
    v_lshl_add_u32 v230, v237, 4, v238
    s_mul_i32 s43, s28, 192
    s_add_u32 s39, s43, 768
    v_add_u32 v236, s39, v250
    v_mul_u32_u24 v237, 2731, v236
    v_lshrrev_b32 v237, 16, v237
    v_mul_u32_u24 v238, 24, v237
    v_sub_u32 v238, v236, v238
    v_bfe_u32 v239, v237, 1, 1
    v_bfe_u32 v240, v237, 3, 1
    v_lshl_or_b32 v239, v240, 1, v239
    v_lshrrev_b32 v240, 1, v238
    v_xor_b32 v240, v240, v239
    v_cmp_le_u32 vcc, 6, v240
    s_nop 1
    v_cndmask_b32 v241, 0, 1, vcc
    v_mul_u32_u24 v242, 6, v241
    v_sub_u32 v242, v240, v242
    v_lshrrev_b32 v243, 1, v242
    v_and_b32 v242, 1, v242
    v_lshlrev_b32 v243, 11, v243
    v_lshl_add_u32 v243, v241, 6, v243
    v_lshl_add_u32 v243, v242, 5, v243
    v_and_b32 v242, 1, v238
    v_lshl_add_u32 v243, v242, 4, v243
    s_lshl_b32 s39, s30, 7
    v_add_u32 v243, s39, v243
    v_mul_u32_u24 v237, 6144, v237
    v_add_u32 v231, v237, v243
    s_add_u32 s39, s43, 832
    v_add_u32 v236, s39, v250
    v_mul_u32_u24 v237, 2731, v236
    v_lshrrev_b32 v237, 16, v237
    v_mul_u32_u24 v238, 24, v237
    v_sub_u32 v238, v236, v238
    v_bfe_u32 v239, v237, 1, 1
    v_bfe_u32 v240, v237, 3, 1
    v_lshl_or_b32 v239, v240, 1, v239
    v_lshrrev_b32 v240, 1, v238
    v_xor_b32 v240, v240, v239
    v_cmp_le_u32 vcc, 6, v240
    s_nop 1
    v_cndmask_b32 v241, 0, 1, vcc
    v_mul_u32_u24 v242, 6, v241
    v_sub_u32 v242, v240, v242
    v_lshrrev_b32 v243, 1, v242
    v_and_b32 v242, 1, v242
    v_lshlrev_b32 v243, 11, v243
    v_lshl_add_u32 v243, v241, 6, v243
    v_lshl_add_u32 v243, v242, 5, v243
    v_and_b32 v242, 1, v238
    v_lshl_add_u32 v243, v242, 4, v243
    s_lshl_b32 s39, s30, 7
    v_add_u32 v243, s39, v243
    v_mul_u32_u24 v237, 6144, v237
    v_add_u32 v232, v237, v243
    s_add_u32 s39, s43, 896
    v_add_u32 v236, s39, v250
    v_mul_u32_u24 v237, 2731, v236
    v_lshrrev_b32 v237, 16, v237
    v_mul_u32_u24 v238, 24, v237
    v_sub_u32 v238, v236, v238
    v_bfe_u32 v239, v237, 1, 1
    v_bfe_u32 v240, v237, 3, 1
    v_lshl_or_b32 v239, v240, 1, v239
    v_lshrrev_b32 v240, 1, v238
    v_xor_b32 v240, v240, v239
    v_cmp_le_u32 vcc, 6, v240
    s_nop 1
    v_cndmask_b32 v241, 0, 1, vcc
    v_mul_u32_u24 v242, 6, v241
    v_sub_u32 v242, v240, v242
    v_lshrrev_b32 v243, 1, v242
    v_and_b32 v242, 1, v242
    v_lshlrev_b32 v243, 11, v243
    v_lshl_add_u32 v243, v241, 6, v243
    v_lshl_add_u32 v243, v242, 5, v243
    v_and_b32 v242, 1, v238
    v_lshl_add_u32 v243, v242, 4, v243
    s_lshl_b32 s39, s30, 7
    v_add_u32 v243, s39, v243
    v_mul_u32_u24 v237, 6144, v237
    v_add_u32 v233, v237, v243
    s_lshl_b32 s32, s29, 8
    s_and_b32 s32, s32, 0x7ff
    s_mul_i32 s33, s29, 786432
    s_mov_b32 s41, s32
    s_lshl_b32 s34, s28, 12
    s_add_u32 s34, s34, 0
    s_mul_i32 s35, s28, 3072
    s_add_u32 s35, s35, 77824
    s_mov_b32 s37, 0
    s_add_u32 m0, s34, 0
    s_add_u32 s39, s32, 0
    buffer_load_dwordx4 v230, s[96:99], s39 offen lds
    s_add_u32 m0, s34, 1024
    s_add_u32 s39, s32, 16384
    buffer_load_dwordx4 v230, s[96:99], s39 offen lds
    s_add_u32 m0, s34, 2048
    s_add_u32 s39, s32, 32768
    buffer_load_dwordx4 v230, s[96:99], s39 offen lds
    s_add_u32 m0, s34, 3072
    s_add_u32 s39, s32, 49152
    buffer_load_dwordx4 v230, s[96:99], s39 offen lds
    s_add_u32 s32, s32, 128
    s_and_b32 s32, s32, 0x7ff
    s_xor_b32 s34, s34, 16384
    s_add_u32 m0, s35, 0
    s_nop 0
    buffer_load_dwordx4 v231, s[16:19], s33 offen lds
    s_add_u32 m0, s35, 1024
    s_nop 0
    buffer_load_dwordx4 v232, s[16:19], s33 offen lds
    s_add_u32 m0, s35, 2048
    s_nop 0
    buffer_load_dwordx4 v233, s[16:19], s33 offen lds
    s_add_u32 s33, s33, 393216
    s_cmp_eq_u32 s33, 6291456
    s_cselect_b32 s33, 0, s33
    s_add_u32 s37, s37, 1
    s_add_u32 s35, s35, 28672
    s_cmp_eq_u32 s37, 3
    s_cselect_b32 s39, 86016, 0
    s_cselect_b32 s37, 0, s37
    s_sub_u32 s35, s35, s39
    s_add_u32 m0, s34, 0
    s_add_u32 s39, s32, 0
    buffer_load_dwordx4 v230, s[96:99], s39 offen lds
    s_add_u32 m0, s34, 1024
    s_add_u32 s39, s32, 16384
    buffer_load_dwordx4 v230, s[96:99], s39 offen lds
    s_add_u32 m0, s34, 2048
    s_add_u32 s39, s32, 32768
    buffer_load_dwordx4 v230, s[96:99], s39 offen lds
    s_add_u32 m0, s34, 3072
    s_add_u32 s39, s32, 49152
    buffer_load_dwordx4 v230, s[96:99], s39 offen lds
    s_add_u32 s32, s32, 128
    s_and_b32 s32, s32, 0x7ff
    s_xor_b32 s34, s34, 16384
    s_add_u32 m0, s35, 0
    s_nop 0
    buffer_load_dwordx4 v231, s[16:19], s33 offen lds
    s_add_u32 m0, s35, 1024
    s_nop 0
    buffer_load_dwordx4 v232, s[16:19], s33 offen lds
    s_add_u32 m0, s35, 2048
    s_nop 0
    buffer_load_dwordx4 v233, s[16:19], s33 offen lds
    s_add_u32 s33, s33, 393216
    s_cmp_eq_u32 s33, 6291456
    s_cselect_b32 s33, 0, s33
    s_add_u32 s37, s37, 1
    s_add_u32 s35, s35, 28672
    s_cmp_eq_u32 s37, 3
    s_cselect_b32 s39, 86016, 0
    s_cselect_b32 s37, 0, s37
    s_sub_u32 s35, s35, s39
    s_and_b32 s93, s93, 0xffff
    s_and_b32 s95, s95, 0xffff
    s_lshl_b32 s70, s2, 3
    s_add_u32 s70, s70, s24
    s_lshl_b32 s70, s70, 10
    v_lshlrev_b32 v216, 4, v250
    s_mov_b32 s71, 786432
    s_mov_b32 s91, 0
    s_add_u32 s64, s8, 29360128
    s_addc_u32 s65, s9, 0
    s_and_b32 s65, s65, 0xffff
    s_mov_b32 s66, 327680
    s_mov_b32 s67, 0x20000
    s_mov_b32 s72, s78
    s_and_b32 s73, s79, 0xffff
    s_mov_b32 s74, 256
    s_mov_b32 s75, 0x20000
    s_add_u32 s76, s30, 0
    s_mov_b32 s77, 57348
    s_lshl_b32 s39, s29, 8
    s_lshl_b32 s42, s76, 3
    s_add_u32 s39, s39, s42
    s_lshl_b32 s42, s28, 1
    s_add_u32 s91, s39, s42
    s_lshl_b32 s39, s91, 11
    buffer_load_dwordx4 v[112:115], v216, s[12:15], s39 offen offset:0
    buffer_load_dwordx4 v[116:119], v216, s[12:15], s39 offen offset:1024
    buffer_load_dwordx4 v[120:123], v216, s[12:15], s39 offen offset:2048
    buffer_load_dwordx4 v[124:127], v216, s[12:15], s39 offen offset:3072
    s_mul_i32 s39, s27, 6
    s_add_u32 s44, s39, 0
    s_add_u32 s45, s39, 1
    s_add_u32 s46, s39, 2
    s_add_u32 s47, s39, 3
    s_add_u32 s48, s39, 4
    s_add_u32 s49, s39, 5
    v_and_b32 v236, 7, v251
    v_xor_b32 v236, v252, v236
    v_lshlrev_b32 v236, 4, v236
    v_lshl_add_u32 v236, v251, 7, v236
    s_lshl_b32 s39, s26, 13
    s_add_u32 s39, s39, 32768
    s_lshl_b32 s42, s27, 12
    s_add_u32 s43, s39, s42
    v_add_u32 v217, s43, v236
    v_xor_b32 v218, 64, v217
    s_xor_b32 s42, s42, 4096
    s_add_u32 s43, s39, s42
    v_add_u32 v219, s43, v236
    v_xor_b32 v220, 64, v219
    v_lshrrev_b32 v236, 2, v251
    v_lshl_add_u32 v237, v252, 3, v236
    v_mul_u32_u24 v237, 384, v237
    v_and_b32 v238, 3, v250
    v_lshl_add_u32 v237, v238, 3, v237
    v_add_u32 v237, 65536, v237
    v_and_b32 v238, 1, v252
    v_lshrrev_b32 v239, 1, v236
    v_lshl_or_b32 v238, v238, 1, v239
    v_xor_b32 v239, s44, v238
    v_lshl_add_u32 v221, v239, 5, v237
    v_xor_b32 v239, s45, v238
    v_lshl_add_u32 v222, v239, 5, v237
    v_xor_b32 v239, s46, v238
    v_lshl_add_u32 v223, v239, 5, v237
    v_xor_b32 v239, s47, v238
    v_lshl_add_u32 v224, v239, 5, v237
    v_xor_b32 v239, s48, v238
    v_lshl_add_u32 v225, v239, 5, v237
    v_xor_b32 v239, s49, v238
    v_lshl_add_u32 v226, v239, 5, v237
    v_mov_b32 v0, 0
    v_mov_b32 v1, 0
    v_mov_b32 v2, 0
    v_mov_b32 v3, 0
    v_mov_b32 v4, 0
    v_mov_b32 v5, 0
    v_mov_b32 v6, 0
    v_mov_b32 v7, 0
    v_mov_b32 v8, 0
    v_mov_b32 v9, 0
    v_mov_b32 v10, 0
    v_mov_b32 v11, 0
    v_mov_b32 v12, 0
    v_mov_b32 v13, 0
    v_mov_b32 v14, 0
    v_mov_b32 v15, 0
    v_mov_b32 v16, 0
    v_mov_b32 v17, 0
    v_mov_b32 v18, 0
    v_mov_b32 v19, 0
    v_mov_b32 v20, 0
    v_mov_b32 v21, 0
    v_mov_b32 v22, 0
    v_mov_b32 v23, 0
    v_mov_b32 v24, 0
    v_mov_b32 v25, 0
    v_mov_b32 v26, 0
    v_mov_b32 v27, 0
    v_mov_b32 v28, 0
    v_mov_b32 v29, 0
    v_mov_b32 v30, 0
    v_mov_b32 v31, 0
    v_mov_b32 v32, 0
    v_mov_b32 v33, 0
    v_mov_b32 v34, 0
    v_mov_b32 v35, 0
    v_mov_b32 v36, 0
    v_mov_b32 v37, 0
    v_mov_b32 v38, 0
    v_mov_b32 v39, 0
    v_mov_b32 v40, 0
    v_mov_b32 v41, 0
    v_mov_b32 v42, 0
    v_mov_b32 v43, 0
    v_mov_b32 v44, 0
    v_mov_b32 v45, 0
    v_mov_b32 v46, 0
    v_mov_b32 v47, 0
    v_mov_b32 v48, 0
    v_mov_b32 v49, 0
    v_mov_b32 v50, 0
    v_mov_b32 v51, 0
    v_mov_b32 v52, 0
    v_mov_b32 v53, 0
    v_mov_b32 v54, 0
    v_mov_b32 v55, 0
    v_mov_b32 v56, 0
    v_mov_b32 v57, 0
    v_mov_b32 v58, 0
    v_mov_b32 v59, 0
    v_mov_b32 v60, 0
    v_mov_b32 v61, 0
    v_mov_b32 v62, 0
    v_mov_b32 v63, 0
    v_mov_b32 v64, 0
    v_mov_b32 v65, 0
    v_mov_b32 v66, 0
    v_mov_b32 v67, 0
    v_mov_b32 v68, 0
    v_mov_b32 v69, 0
    v_mov_b32 v70, 0
    v_mov_b32 v71, 0
    v_mov_b32 v72, 0
    v_mov_b32 v73, 0
    v_mov_b32 v74, 0
    v_mov_b32 v75, 0
    v_mov_b32 v76, 0
    v_mov_b32 v77, 0
    v_mov_b32 v78, 0
    v_mov_b32 v79, 0
    v_mov_b32 v80, 0
    v_mov_b32 v81, 0
    v_mov_b32 v82, 0
    v_mov_b32 v83, 0
    v_mov_b32 v84, 0
    v_mov_b32 v85, 0
    v_mov_b32 v86, 0
    v_mov_b32 v87, 0
    v_mov_b32 v88, 0
    v_mov_b32 v89, 0
    v_mov_b32 v90, 0
    v_mov_b32 v91, 0
    v_mov_b32 v92, 0
    v_mov_b32 v93, 0
    v_mov_b32 v94, 0
    v_mov_b32 v95, 0
    v_mov_b32 v208, 0
    v_mov_b32 v209, 0
    v_mov_b32 v210, 0
    v_mov_b32 v211, 0
    v_mov_b32 v212, 0
    v_mov_b32 v213, 0
    v_mov_b32 v214, 0
    v_mov_b32 v215, 0
    v_mov_b32 v240, 0x3f803f80
    v_mov_b32 v241, 0x3f803f80
    v_mov_b32 v242, 0x3f803f80
    v_mov_b32 v243, 0x3f803f80
    s_mov_b32 s60, 28672
    s_mov_b32 s31, 0
    s_mov_b32 s38, 0
    s_waitcnt vmcnt(11)
    s_barrier
    s_waitcnt vmcnt(0)
    v_lshlrev_b32 v144, 16, v112
    v_and_b32 v145, 0xffff0000, v112
    v_lshlrev_b32 v146, 16, v113
    v_and_b32 v147, 0xffff0000, v113
    v_lshlrev_b32 v148, 16, v114
    v_and_b32 v149, 0xffff0000, v114
    v_lshlrev_b32 v150, 16, v115
    v_and_b32 v151, 0xffff0000, v115
    v_lshlrev_b32 v152, 16, v116
    v_and_b32 v153, 0xffff0000, v116
    v_lshlrev_b32 v154, 16, v117
    v_and_b32 v155, 0xffff0000, v117
    v_lshlrev_b32 v156, 16, v118
    v_and_b32 v157, 0xffff0000, v118
    v_lshlrev_b32 v158, 16, v119
    v_and_b32 v159, 0xffff0000, v119
    v_pk_add_f32 v[160:161], v[144:145], v[146:147]
    v_pk_add_f32 v[160:161], v[160:161], v[148:149]
    v_pk_add_f32 v[160:161], v[160:161], v[150:151]
    v_pk_add_f32 v[160:161], v[160:161], v[152:153]
    v_pk_add_f32 v[160:161], v[160:161], v[154:155]
    v_pk_add_f32 v[160:161], v[160:161], v[156:157]
    v_pk_add_f32 v[160:161], v[160:161], v[158:159]
    v_add_f32 v164, v160, v161
    s_nop 1
    v_add_f32_dpp v165, v164, v164 quad_perm:[1,0,3,2] row_mask:0xf bank_mask:0xf
    s_nop 1
    v_add_f32_dpp v164, v165, v165 quad_perm:[2,3,0,1] row_mask:0xf bank_mask:0xf
    s_nop 1
    v_add_f32_dpp v165, v164, v164 row_half_mirror row_mask:0xf bank_mask:0xf
    s_nop 1
    v_add_f32_dpp v164, v165, v165 row_mirror row_mask:0xf bank_mask:0xf
    v_mov_b32 v165, v164
    s_nop 1
    v_permlane16_swap_b32 v164, v165
    s_nop 1
    v_add_f32 v164, v164, v165
    v_mov_b32 v165, v164
    s_nop 1
    v_permlane32_swap_b32 v164, v165
    s_nop 1
    v_add_f32 v164, v164, v165
    v_mul_f32 v164, 0x3a800000, v164
    v_pk_add_f32 v[144:145], v[144:145], v[164:165] op_sel_hi:[1,0] neg_lo:[0,1] neg_hi:[0,1]
    v_pk_add_f32 v[146:147], v[146:147], v[164:165] op_sel_hi:[1,0] neg_lo:[0,1] neg_hi:[0,1]
    v_pk_add_f32 v[148:149], v[148:149], v[164:165] op_sel_hi:[1,0] neg_lo:[0,1] neg_hi:[0,1]
    v_pk_add_f32 v[150:151], v[150:151], v[164:165] op_sel_hi:[1,0] neg_lo:[0,1] neg_hi:[0,1]
    v_pk_add_f32 v[152:153], v[152:153], v[164:165] op_sel_hi:[1,0] neg_lo:[0,1] neg_hi:[0,1]
    v_pk_add_f32 v[154:155], v[154:155], v[164:165] op_sel_hi:[1,0] neg_lo:[0,1] neg_hi:[0,1]
    v_pk_add_f32 v[156:157], v[156:157], v[164:165] op_sel_hi:[1,0] neg_lo:[0,1] neg_hi:[0,1]
    v_pk_add_f32 v[158:159], v[158:159], v[164:165] op_sel_hi:[1,0] neg_lo:[0,1] neg_hi:[0,1]
    v_pk_mul_f32 v[160:161], v[144:145], v[144:145]
    v_pk_fma_f32 v[160:161], v[146:147], v[146:147], v[160:161]
    v_pk_fma_f32 v[160:161], v[148:149], v[148:149], v[160:161]
    v_pk_fma_f32 v[160:161], v[150:151], v[150:151], v[160:161]
    v_pk_fma_f32 v[160:161], v[152:153], v[152:153], v[160:161]
    v_pk_fma_f32 v[160:161], v[154:155], v[154:155], v[160:161]
    v_pk_fma_f32 v[160:161], v[156:157], v[156:157], v[160:161]
    v_pk_fma_f32 v[160:161], v[158:159], v[158:159], v[160:161]
    v_add_f32 v161, v160, v161
    s_nop 1
    v_add_f32_dpp v165, v161, v161 quad_perm:[1,0,3,2] row_mask:0xf bank_mask:0xf
    s_nop 1
    v_add_f32_dpp v161, v165, v165 quad_perm:[2,3,0,1] row_mask:0xf bank_mask:0xf
    s_nop 1
    v_add_f32_dpp v165, v161, v161 row_half_mirror row_mask:0xf bank_mask:0xf
    s_nop 1
    v_add_f32_dpp v161, v165, v165 row_mirror row_mask:0xf bank_mask:0xf
    v_mov_b32 v165, v161
    s_nop 1
    v_permlane16_swap_b32 v161, v165
    s_nop 1
    v_add_f32 v161, v161, v165
    v_mov_b32 v165, v161
    s_nop 1
    v_permlane32_swap_b32 v161, v165
    s_nop 1
    v_add_f32 v161, v161, v165
    v_mul_f32 v161, 0x3a800000, v161
    v_cvt_pk_bf16_f32 v165, v164, v161
    v_lshlrev_b32 v160, 16, v165
    v_and_b32 v161, 0xffff0000, v165
    v_add_f32 v161, 0x3727c5ac, v161
    v_cvt_pk_bf16_f32 v161, v161, v161
    v_and_b32 v161, 0xffff0000, v161
    v_sqrt_f32 v161, v161
    s_nop 0
    v_cvt_pk_bf16_f32 v161, v161, v161
    v_and_b32 v161, 0xffff0000, v161
    v_rcp_f32 v161, v161
    s_nop 0
    v_lshlrev_b32 v144, 16, v120
    v_and_b32 v145, 0xffff0000, v120
    v_lshlrev_b32 v146, 16, v121
    v_and_b32 v147, 0xffff0000, v121
    v_lshlrev_b32 v148, 16, v122
    v_and_b32 v149, 0xffff0000, v122
    v_lshlrev_b32 v150, 16, v123
    v_and_b32 v151, 0xffff0000, v123
    v_lshlrev_b32 v152, 16, v124
    v_and_b32 v153, 0xffff0000, v124
    v_lshlrev_b32 v154, 16, v125
    v_and_b32 v155, 0xffff0000, v125
    v_lshlrev_b32 v156, 16, v126
    v_and_b32 v157, 0xffff0000, v126
    v_lshlrev_b32 v158, 16, v127
    v_and_b32 v159, 0xffff0000, v127
    v_pk_add_f32 v[162:163], v[144:145], v[146:147]
    v_pk_add_f32 v[162:163], v[162:163], v[148:149]
    v_pk_add_f32 v[162:163], v[162:163], v[150:151]
    v_pk_add_f32 v[162:163], v[162:163], v[152:153]
    v_pk_add_f32 v[162:163], v[162:163], v[154:155]
    v_pk_add_f32 v[162:163], v[162:163], v[156:157]
    v_pk_add_f32 v[162:163], v[162:163], v[158:159]
    v_add_f32 v164, v162, v163
    s_nop 1
    v_add_f32_dpp v165, v164, v164 quad_perm:[1,0,3,2] row_mask:0xf bank_mask:0xf
    s_nop 1
    v_add_f32_dpp v164, v165, v165 quad_perm:[2,3,0,1] row_mask:0xf bank_mask:0xf
    s_nop 1
    v_add_f32_dpp v165, v164, v164 row_half_mirror row_mask:0xf bank_mask:0xf
    s_nop 1
    v_add_f32_dpp v164, v165, v165 row_mirror row_mask:0xf bank_mask:0xf
    v_mov_b32 v165, v164
    s_nop 1
    v_permlane16_swap_b32 v164, v165
    s_nop 1
    v_add_f32 v164, v164, v165
    v_mov_b32 v165, v164
    s_nop 1
    v_permlane32_swap_b32 v164, v165
    s_nop 1
    v_add_f32 v164, v164, v165
    v_mul_f32 v164, 0x3a800000, v164
    v_pk_add_f32 v[144:145], v[144:145], v[164:165] op_sel_hi:[1,0] neg_lo:[0,1] neg_hi:[0,1]
    v_pk_add_f32 v[146:147], v[146:147], v[164:165] op_sel_hi:[1,0] neg_lo:[0,1] neg_hi:[0,1]
    v_pk_add_f32 v[148:149], v[148:149], v[164:165] op_sel_hi:[1,0] neg_lo:[0,1] neg_hi:[0,1]
    v_pk_add_f32 v[150:151], v[150:151], v[164:165] op_sel_hi:[1,0] neg_lo:[0,1] neg_hi:[0,1]
    v_pk_add_f32 v[152:153], v[152:153], v[164:165] op_sel_hi:[1,0] neg_lo:[0,1] neg_hi:[0,1]
    v_pk_add_f32 v[154:155], v[154:155], v[164:165] op_sel_hi:[1,0] neg_lo:[0,1] neg_hi:[0,1]
    v_pk_add_f32 v[156:157], v[156:157], v[164:165] op_sel_hi:[1,0] neg_lo:[0,1] neg_hi:[0,1]
    v_pk_add_f32 v[158:159], v[158:159], v[164:165] op_sel_hi:[1,0] neg_lo:[0,1] neg_hi:[0,1]
    v_pk_mul_f32 v[162:163], v[144:145], v[144:145]
    v_pk_fma_f32 v[162:163], v[146:147], v[146:147], v[162:163]
    v_pk_fma_f32 v[162:163], v[148:149], v[148:149], v[162:163]
    v_pk_fma_f32 v[162:163], v[150:151], v[150:151], v[162:163]
    v_pk_fma_f32 v[162:163], v[152:153], v[152:153], v[162:163]
    v_pk_fma_f32 v[162:163], v[154:155], v[154:155], v[162:163]
    v_pk_fma_f32 v[162:163], v[156:157], v[156:157], v[162:163]
    v_pk_fma_f32 v[162:163], v[158:159], v[158:159], v[162:163]
    v_add_f32 v163, v162, v163
    s_nop 1
    v_add_f32_dpp v165, v163, v163 quad_perm:[1,0,3,2] row_mask:0xf bank_mask:0xf
    s_nop 1
    v_add_f32_dpp v163, v165, v165 quad_perm:[2,3,0,1] row_mask:0xf bank_mask:0xf
    s_nop 1
    v_add_f32_dpp v165, v163, v163 row_half_mirror row_mask:0xf bank_mask:0xf
    s_nop 1
    v_add_f32_dpp v163, v165, v165 row_mirror row_mask:0xf bank_mask:0xf
    v_mov_b32 v165, v163
    s_nop 1
    v_permlane16_swap_b32 v163, v165
    s_nop 1
    v_add_f32 v163, v163, v165
    v_mov_b32 v165, v163
    s_nop 1
    v_permlane32_swap_b32 v163, v165
    s_nop 1
    v_add_f32 v163, v163, v165
    v_mul_f32 v163, 0x3a800000, v163
    v_cvt_pk_bf16_f32 v165, v164, v163
    v_lshlrev_b32 v162, 16, v165
    v_and_b32 v163, 0xffff0000, v165
    v_add_f32 v163, 0x3727c5ac, v163
    v_cvt_pk_bf16_f32 v163, v163, v163
    v_and_b32 v163, 0xffff0000, v163
    v_sqrt_f32 v163, v163
    s_nop 0
    v_cvt_pk_bf16_f32 v163, v163, v163
    v_and_b32 v163, 0xffff0000, v163
    v_rcp_f32 v163, v163
    s_nop 0
    v_lshlrev_b32 v164, 24, v250
    s_lshl_b32 s39, s91, 3
    buffer_store_dwordx4 v[160:163], v164, s[64:67], s39 offen sc0 sc1
    s_barrier
    s_mov_b32 s25, s34
    s_mov_b32 s3, s35
.p2align 6
g1_01_loop:
    ds_read_b128 v[112:115], v217 offset:0
    ds_read_b128 v[120:123], v217 offset:2048
    s_add_u32 m0, s25, 0
    s_add_u32 s39, s32, 0
    buffer_load_dwordx4 v230, s[96:99], s39 offen lds
    ds_read_b128 v[128:131], v219 offset:0
    ds_read_b128 v[136:139], v219 offset:2048
    ds_read_b64_tr_b16 v[144:145], v221 offset:0
    ds_read_b64_tr_b16 v[146:147], v221 offset:1536
    s_add_u32 m0, s25, 1024
    s_add_u32 s39, s32, 16384
    buffer_load_dwordx4 v230, s[96:99], s39 offen lds
    ds_read_b64_tr_b16 v[152:153], v222 offset:0
    ds_read_b64_tr_b16 v[154:155], v222 offset:1536
    ds_read_b64_tr_b16 v[160:161], v223 offset:0
    ds_read_b64_tr_b16 v[162:163], v223 offset:1536
    s_add_u32 m0, s25, 2048
    s_add_u32 s39, s32, 32768
    buffer_load_dwordx4 v230, s[96:99], s39 offen lds
    ds_read_b64_tr_b16 v[168:169], v224 offset:0
    ds_read_b64_tr_b16 v[170:171], v224 offset:1536
    ds_read_b64_tr_b16 v[176:177], v225 offset:0
    ds_read_b64_tr_b16 v[178:179], v225 offset:1536
    s_add_u32 m0, s25, 3072
    s_add_u32 s39, s32, 49152
    buffer_load_dwordx4 v230, s[96:99], s39 offen lds
    ds_read_b64_tr_b16 v[184:185], v226 offset:0
    ds_read_b64_tr_b16 v[186:187], v226 offset:1536
    ds_read_b128 v[116:119], v218 offset:0
    ds_read_b128 v[124:127], v218 offset:2048
    s_add_u32 m0, s3, 0
    s_nop 0
    buffer_load_dwordx4 v231, s[16:19], s33 offen lds
    ds_read_b128 v[132:135], v220 offset:0
    ds_read_b128 v[140:143], v220 offset:2048
    ds_read_b64_tr_b16 v[148:149], v221 offset:12288
    ds_read_b64_tr_b16 v[150:151], v221 offset:13824
    s_add_u32 m0, s3, 1024
    s_nop 0
    buffer_load_dwordx4 v232, s[16:19], s33 offen lds
    ds_read_b64_tr_b16 v[156:157], v222 offset:12288
    ds_read_b64_tr_b16 v[158:159], v222 offset:13824
    ds_read_b64_tr_b16 v[164:165], v223 offset:12288
    ds_read_b64_tr_b16 v[166:167], v223 offset:13824
    s_add_u32 m0, s3, 2048
    s_nop 0
    buffer_load_dwordx4 v233, s[16:19], s33 offen lds
    ds_read_b64_tr_b16 v[172:173], v224 offset:12288
    ds_read_b64_tr_b16 v[174:175], v224 offset:13824
    ds_read_b64_tr_b16 v[180:181], v225 offset:12288
    ds_read_b64_tr_b16 v[182:183], v225 offset:13824
    ds_read_b64_tr_b16 v[188:189], v226 offset:12288
    ds_read_b64_tr_b16 v[190:191], v226 offset:13824
    s_bitcmp1_b32 s77, s31
    s_cbranch_scc1 g1_01_event
    s_waitcnt vmcnt(7) lgkmcnt(0)
g1_01_afterwait:
    s_barrier
    s_setprio 1
    v_mfma_f32_16x16x32_bf16 v[0:3], v[144:147], v[112:115], v[0:3]
    v_mfma_f32_16x16x32_bf16 v[4:7], v[144:147], v[120:123], v[4:7]
    v_mfma_f32_16x16x32_bf16 v[8:11], v[144:147], v[128:131], v[8:11]
    s_add_u32 s32, s32, 128
    v_mfma_f32_16x16x32_bf16 v[12:15], v[144:147], v[136:139], v[12:15]
    s_and_b32 s32, s32, 0x7ff
    v_mfma_f32_16x16x32_bf16 v[16:19], v[152:155], v[112:115], v[16:19]
    s_xor_b32 s34, s34, 16384
    v_mfma_f32_16x16x32_bf16 v[20:23], v[152:155], v[120:123], v[20:23]
    s_cmp_ge_u32 s31, 13
    v_mfma_f32_16x16x32_bf16 v[24:27], v[152:155], v[128:131], v[24:27]
    s_cselect_b32 s98, 0, s98
    v_mfma_f32_16x16x32_bf16 v[28:31], v[152:155], v[136:139], v[28:31]
    s_cselect_b32 s25, 163840, s34
    v_mfma_f32_16x16x32_bf16 v[32:35], v[160:163], v[112:115], v[32:35]
    s_add_u32 s41, s41, 128
    v_mfma_f32_16x16x32_bf16 v[36:39], v[160:163], v[120:123], v[36:39]
    s_and_b32 s41, s41, 0x7ff
    v_mfma_f32_16x16x32_bf16 v[40:43], v[160:163], v[128:131], v[40:43]
    s_add_u32 s91, s91, s71
    v_mfma_f32_16x16x32_bf16 v[44:47], v[160:163], v[136:139], v[44:47]
    s_add_u32 s33, s33, 393216
    v_mfma_f32_16x16x32_bf16 v[48:51], v[168:171], v[112:115], v[48:51]
    s_cmp_eq_u32 s33, 6291456
    v_mfma_f32_16x16x32_bf16 v[52:55], v[168:171], v[120:123], v[52:55]
    s_cselect_b32 s33, 0, s33
    v_mfma_f32_16x16x32_bf16 v[56:59], v[168:171], v[128:131], v[56:59]
    s_add_u32 s37, s37, 1
    v_mfma_f32_16x16x32_bf16 v[60:63], v[168:171], v[136:139], v[60:63]
    s_add_u32 s35, s35, 28672
    v_mfma_f32_16x16x32_bf16 v[64:67], v[176:179], v[112:115], v[64:67]
    s_cmp_eq_u32 s37, 3
    v_mfma_f32_16x16x32_bf16 v[68:71], v[176:179], v[120:123], v[68:71]
    s_cselect_b32 s39, 86016, 0
    v_mfma_f32_16x16x32_bf16 v[72:75], v[176:179], v[128:131], v[72:75]
    s_cselect_b32 s37, 0, s37
    v_mfma_f32_16x16x32_bf16 v[76:79], v[176:179], v[136:139], v[76:79]
    s_sub_u32 s35, s35, s39
    v_mfma_f32_16x16x32_bf16 v[80:83], v[184:187], v[112:115], v[80:83]
    s_cmp_ge_u32 s31, 13
    v_mfma_f32_16x16x32_bf16 v[84:87], v[184:187], v[120:123], v[84:87]
    s_cselect_b32 s3, 163840, s35
    v_mfma_f32_16x16x32_bf16 v[88:91], v[184:187], v[128:131], v[88:91]
    s_cselect_b32 s18, 0, s18
    v_mfma_f32_16x16x32_bf16 v[92:95], v[184:187], v[136:139], v[92:95]
    s_cselect_b32 s14, 0, s14
    v_mfma_f32_16x16x32_bf16 v[0:3], v[148:151], v[116:119], v[0:3]
    s_add_u32 s38, s38, 1
    v_mfma_f32_16x16x32_bf16 v[4:7], v[148:151], v[124:127], v[4:7]
    s_cmp_eq_u32 s38, 3
    v_mfma_f32_16x16x32_bf16 v[8:11], v[148:151], v[132:135], v[8:11]
    s_cselect_b32 s36, 4294909952, s60
    v_mfma_f32_16x16x32_bf16 v[12:15], v[148:151], v[140:143], v[12:15]
    s_cselect_b32 s38, 0, s38
    v_mfma_f32_16x16x32_bf16 v[16:19], v[156:159], v[116:119], v[16:19]
    v_xor_b32 v217, 16384, v217
    v_mfma_f32_16x16x32_bf16 v[20:23], v[156:159], v[124:127], v[20:23]
    v_xor_b32 v218, 16384, v218
    v_mfma_f32_16x16x32_bf16 v[24:27], v[156:159], v[132:135], v[24:27]
    v_xor_b32 v219, 16384, v219
    v_mfma_f32_16x16x32_bf16 v[28:31], v[156:159], v[140:143], v[28:31]
    v_xor_b32 v220, 16384, v220
    v_mfma_f32_16x16x32_bf16 v[32:35], v[164:167], v[116:119], v[32:35]
    v_add_u32 v221, s36, v221
    v_mfma_f32_16x16x32_bf16 v[36:39], v[164:167], v[124:127], v[36:39]
    v_add_u32 v222, s36, v222
    v_mfma_f32_16x16x32_bf16 v[40:43], v[164:167], v[132:135], v[40:43]
    v_add_u32 v223, s36, v223
    v_mfma_f32_16x16x32_bf16 v[44:47], v[164:167], v[140:143], v[44:47]
    v_add_u32 v224, s36, v224
    v_mfma_f32_16x16x32_bf16 v[48:51], v[172:175], v[116:119], v[48:51]
    v_add_u32 v225, s36, v225
    v_mfma_f32_16x16x32_bf16 v[52:55], v[172:175], v[124:127], v[52:55]
    v_add_u32 v226, s36, v226
    v_mfma_f32_16x16x32_bf16 v[56:59], v[172:175], v[132:135], v[56:59]
    v_mfma_f32_16x16x32_bf16 v[60:63], v[172:175], v[140:143], v[60:63]
    v_mfma_f32_16x16x32_bf16 v[64:67], v[180:183], v[116:119], v[64:67]
    v_mfma_f32_16x16x32_bf16 v[68:71], v[180:183], v[124:127], v[68:71]
    v_mfma_f32_16x16x32_bf16 v[72:75], v[180:183], v[132:135], v[72:75]
    v_mfma_f32_16x16x32_bf16 v[76:79], v[180:183], v[140:143], v[76:79]
    v_mfma_f32_16x16x32_bf16 v[80:83], v[188:191], v[116:119], v[80:83]
    v_mfma_f32_16x16x32_bf16 v[84:87], v[188:191], v[124:127], v[84:87]
    v_mfma_f32_16x16x32_bf16 v[88:91], v[188:191], v[132:135], v[88:91]
    v_mfma_f32_16x16x32_bf16 v[92:95], v[188:191], v[140:143], v[92:95]
    s_cmp_lt_u32 s31, 2
    s_cbranch_scc0 g1_01_nocs
    v_mfma_f32_16x16x32_bf16 v[208:211], v[144:147], v[240:243], v[208:211]
    v_mfma_f32_16x16x32_bf16 v[212:215], v[152:155], v[240:243], v[212:215]
    v_mfma_f32_16x16x32_bf16 v[208:211], v[148:151], v[240:243], v[208:211]
    v_mfma_f32_16x16x32_bf16 v[212:215], v[156:159], v[240:243], v[212:215]
g1_01_nocs:
    s_setprio 0
    s_add_u32 s31, s31, 1
    s_cmp_lt_u32 s31, 16
    s_cbranch_scc0 g1_01_post
    s_barrier
    s_branch g1_01_loop
g1_01_event:
    s_cmp_eq_u32 s31, 15
    s_cbranch_scc0 g1_01_evn15
    s_waitcnt vmcnt(19) lgkmcnt(0)
    s_branch g1_01_afterwait
g1_01_evn15:
    s_cmp_eq_u32 s31, 2
    s_cbranch_scc1 g1_01_ev2
    s_cmp_eq_u32 s31, 14
    s_cbranch_scc1 g1_01_evw
    s_mov_b32 s64, s92
    s_mov_b32 s65, s93
    s_mov_b32 s66, 2097152
    s_mov_b32 s72, s94
    s_mov_b32 s73, s95
    s_mov_b32 s74, 7340032
    s_mov_b32 s67, 0x20000
    s_mov_b32 s75, 0x20000
    s_lshl_b32 s39, s70, 2
    buffer_load_dwordx4 v[212:215], v216, s[64:67], s70 offen
    buffer_load_dwordx4 v[212:215], v216, s[72:75], s39 offen offset:0
    buffer_load_dwordx4 v[212:215], v216, s[72:75], s39 offen offset:1024
    buffer_load_dwordx4 v[212:215], v216, s[72:75], s39 offen offset:2048
    buffer_load_dwordx4 v[212:215], v216, s[72:75], s39 offen offset:3072
g1_01_evw:
    s_waitcnt vmcnt(12) lgkmcnt(0)
    s_branch g1_01_afterwait
g1_01_ev2:
    v_lshlrev_b32 v236, 24, v251
    v_lshl_add_u32 v236, v252, 4, v236
    s_lshl_b32 s42, s76, 3
    s_add_u32 s42, s42, s29
    s_lshl_b32 s42, s42, 10
    s_add_u32 s42, s42, 65536
    s_lshl_b32 s39, s44, 6
    s_add_u32 s39, s39, s42
    buffer_store_dwordx4 v[208:211], v236, s[64:67], s39 offen sc0 sc1
    s_lshl_b32 s39, s45, 6
    s_add_u32 s39, s39, s42
    buffer_store_dwordx4 v[212:215], v236, s[64:67], s39 offen sc0 sc1
    s_waitcnt vmcnt(9) lgkmcnt(0)
    s_branch g1_01_afterwait
g1_01_post:
g1_01_red:
    s_barrier
    v_mov_b32 v236, 163712
    ds_read_b32 v237, v236
    s_waitcnt lgkmcnt(0)
    v_readfirstlane_b32 s39, v237
    s_nop 3
    s_cmp_eq_u32 s39, 0
    s_cbranch_scc1 g1_01_fast
    s_barrier
    s_mov_b32 s14, 4194304
    s_mov_b32 s18, 6291456
    s_mov_b32 s31, s24
g1_01_slow1:
    s_lshl_b32 s39, s29, 8
    s_add_u32 s39, s39, s31
    s_sub_u32 s39, s39, 16
    s_max_i32 s39, s39, 0
    s_lshl_b32 s39, s39, 11
    buffer_load_dwordx4 v[112:115], v216, s[12:15], s39 offen
    buffer_load_dwordx4 v[116:119], v216, s[12:15], s39 offen offset:1024
    s_waitcnt vmcnt(0)
    v_lshlrev_b32 v144, 16, v112
    v_and_b32 v145, 0xffff0000, v112
    v_lshlrev_b32 v146, 16, v113
    v_and_b32 v147, 0xffff0000, v113
    v_lshlrev_b32 v148, 16, v114
    v_and_b32 v149, 0xffff0000, v114
    v_lshlrev_b32 v150, 16, v115
    v_and_b32 v151, 0xffff0000, v115
    v_lshlrev_b32 v152, 16, v116
    v_and_b32 v153, 0xffff0000, v116
    v_lshlrev_b32 v154, 16, v117
    v_and_b32 v155, 0xffff0000, v117
    v_lshlrev_b32 v156, 16, v118
    v_and_b32 v157, 0xffff0000, v118
    v_lshlrev_b32 v158, 16, v119
    v_and_b32 v159, 0xffff0000, v119
    v_pk_add_f32 v[160:161], v[144:145], v[146:147]
    v_pk_add_f32 v[160:161], v[160:161], v[148:149]
    v_pk_add_f32 v[160:161], v[160:161], v[150:151]
    v_pk_add_f32 v[160:161], v[160:161], v[152:153]
    v_pk_add_f32 v[160:161], v[160:161], v[154:155]
    v_pk_add_f32 v[160:161], v[160:161], v[156:157]
    v_pk_add_f32 v[160:161], v[160:161], v[158:159]
    v_add_f32 v164, v160, v161
    s_nop 1
    v_add_f32_dpp v165, v164, v164 quad_perm:[1,0,3,2] row_mask:0xf bank_mask:0xf
    s_nop 1
    v_add_f32_dpp v164, v165, v165 quad_perm:[2,3,0,1] row_mask:0xf bank_mask:0xf
    s_nop 1
    v_add_f32_dpp v165, v164, v164 row_half_mirror row_mask:0xf bank_mask:0xf
    s_nop 1
    v_add_f32_dpp v164, v165, v165 row_mirror row_mask:0xf bank_mask:0xf
    v_mov_b32 v165, v164
    s_nop 1
    v_permlane16_swap_b32 v164, v165
    s_nop 1
    v_add_f32 v164, v164, v165
    v_mov_b32 v165, v164
    s_nop 1
    v_permlane32_swap_b32 v164, v165
    s_nop 1
    v_add_f32 v164, v164, v165
    v_mul_f32 v164, 0x3a800000, v164
    v_pk_add_f32 v[144:145], v[144:145], v[164:165] op_sel_hi:[1,0] neg_lo:[0,1] neg_hi:[0,1]
    v_pk_add_f32 v[146:147], v[146:147], v[164:165] op_sel_hi:[1,0] neg_lo:[0,1] neg_hi:[0,1]
    v_pk_add_f32 v[148:149], v[148:149], v[164:165] op_sel_hi:[1,0] neg_lo:[0,1] neg_hi:[0,1]
    v_pk_add_f32 v[150:151], v[150:151], v[164:165] op_sel_hi:[1,0] neg_lo:[0,1] neg_hi:[0,1]
    v_pk_add_f32 v[152:153], v[152:153], v[164:165] op_sel_hi:[1,0] neg_lo:[0,1] neg_hi:[0,1]
    v_pk_add_f32 v[154:155], v[154:155], v[164:165] op_sel_hi:[1,0] neg_lo:[0,1] neg_hi:[0,1]
    v_pk_add_f32 v[156:157], v[156:157], v[164:165] op_sel_hi:[1,0] neg_lo:[0,1] neg_hi:[0,1]
    v_pk_add_f32 v[158:159], v[158:159], v[164:165] op_sel_hi:[1,0] neg_lo:[0,1] neg_hi:[0,1]
    v_pk_mul_f32 v[160:161], v[144:145], v[144:145]
    v_pk_fma_f32 v[160:161], v[146:147], v[146:147], v[160:161]
    v_pk_fma_f32 v[160:161], v[148:149], v[148:149], v[160:161]
    v_pk_fma_f32 v[160:161], v[150:151], v[150:151], v[160:161]
    v_pk_fma_f32 v[160:161], v[152:153], v[152:153], v[160:161]
    v_pk_fma_f32 v[160:161], v[154:155], v[154:155], v[160:161]
    v_pk_fma_f32 v[160:161], v[156:157], v[156:157], v[160:161]
    v_pk_fma_f32 v[160:161], v[158:159], v[158:159], v[160:161]
    v_add_f32 v161, v160, v161
    s_nop 1
    v_add_f32_dpp v165, v161, v161 quad_perm:[1,0,3,2] row_mask:0xf bank_mask:0xf
    s_nop 1
    v_add_f32_dpp v161, v165, v165 quad_perm:[2,3,0,1] row_mask:0xf bank_mask:0xf
    s_nop 1
    v_add_f32_dpp v165, v161, v161 row_half_mirror row_mask:0xf bank_mask:0xf
    s_nop 1
    v_add_f32_dpp v161, v165, v165 row_mirror row_mask:0xf bank_mask:0xf
    v_mov_b32 v165, v161
    s_nop 1
    v_permlane16_swap_b32 v161, v165
    s_nop 1
    v_add_f32 v161, v161, v165
    v_mov_b32 v165, v161
    s_nop 1
    v_permlane32_swap_b32 v161, v165
    s_nop 1
    v_add_f32 v161, v161, v165
    v_mul_f32 v161, 0x3a800000, v161
    v_cvt_pk_bf16_f32 v165, v164, v161
    v_lshlrev_b32 v160, 16, v165
    v_and_b32 v161, 0xffff0000, v165
    v_add_f32 v161, 0x3727c5ac, v161
    v_cvt_pk_bf16_f32 v161, v161, v161
    v_and_b32 v161, 0xffff0000, v161
    v_sqrt_f32 v161, v161
    s_nop 0
    v_cvt_pk_bf16_f32 v161, v161, v161
    v_and_b32 v161, 0xffff0000, v161
    v_rcp_f32 v161, v161
    s_nop 0
    s_lshl_b32 s39, s31, 3
    s_add_u32 s39, s39, 151552
    v_mov_b32 v236, s39
    ds_write_b64 v236, v[160:161]
    s_add_u32 s31, s31, 8
    s_cmp_lt_u32 s31, 272
    s_cbranch_scc1 g1_01_slow1
    v_min_u32 v236, 23, v250
    v_cmp_le_u32 vcc, 12, v236
    s_nop 1
    v_cndmask_b32 v237, 0, 1, vcc
    v_mul_u32_u24 v238, 12, v237
    v_sub_u32 v238, v236, v238
    v_lshrrev_b32 v239, 2, v238
    v_and_b32 v238, 3, v238
    v_lshlrev_b32 v239, 11, v239
    v_lshl_add_u32 v239, v237, 6, v239
    v_lshl_add_u32 v239, v238, 4, v239
    s_lshl_b32 s39, s30, 7
    v_add_u32 v239, s39, v239
    v_mov_b32 v144, 0
    v_mov_b32 v145, 0
    v_mov_b32 v146, 0
    v_mov_b32 v147, 0
    v_mov_b32 v148, 0
    v_mov_b32 v149, 0
    v_mov_b32 v150, 0
    v_mov_b32 v151, 0
    s_mul_i32 s39, s24, 786432
    s_mov_b32 s31, 0
g1_01_slow2:
    buffer_load_dwordx4 v[112:115], v239, s[16:19], s39 offen
    s_add_u32 s39, s39, 6144
    s_add_u32 s31, s31, 1
    s_waitcnt vmcnt(0)
    v_lshlrev_b32 v116, 16, v112
    v_and_b32 v117, 0xffff0000, v112
    v_pk_add_f32 v[144:145], v[144:145], v[116:117]
    v_lshlrev_b32 v116, 16, v113
    v_and_b32 v117, 0xffff0000, v113
    v_pk_add_f32 v[146:147], v[146:147], v[116:117]
    v_lshlrev_b32 v116, 16, v114
    v_and_b32 v117, 0xffff0000, v114
    v_pk_add_f32 v[148:149], v[148:149], v[116:117]
    v_lshlrev_b32 v116, 16, v115
    v_and_b32 v117, 0xffff0000, v115
    v_pk_add_f32 v[150:151], v[150:151], v[116:117]
    s_cmp_lt_u32 s31, 128
    s_cbranch_scc1 g1_01_slow2
    s_lshl_b32 s39, s24, 10
    s_add_u32 s39, s39, 154624
    v_lshl_add_u32 v236, v236, 5, s39
    ds_write_b128 v236, v[144:147]
    ds_write_b128 v236, v[148:151] offset:16
    v_mov_b32 v236, 163712
    v_mov_b32 v237, 0
    ds_write_b32 v236, v237
    s_waitcnt lgkmcnt(0)
    s_barrier
    s_branch g1_01_red
g1_01_fast:
    s_lshl_b32 s39, s26, 6
    s_lshl_b32 s42, s27, 5
    s_xor_b32 s42, s42, 0
    s_add_u32 s39, s39, s42
    s_add_u32 s52, s39, 128
    s_lshl_b32 s39, s26, 6
    s_lshl_b32 s42, s27, 5
    s_xor_b32 s42, s42, 16
    s_add_u32 s39, s39, s42
    s_add_u32 s53, s39, 128
    s_lshl_b32 s39, s26, 6
    s_lshl_b32 s42, s27, 5
    s_xor_b32 s42, s42, 32
    s_add_u32 s39, s39, s42
    s_add_u32 s54, s39, 128
    s_lshl_b32 s39, s26, 6
    s_lshl_b32 s42, s27, 5
    s_xor_b32 s42, s42, 48
    s_add_u32 s39, s39, s42
    s_add_u32 s55, s39, 128
    s_add_u32 s39, s52, 18960
    v_add_u32 v240, s39, v251
    v_lshlrev_b32 v240, 3, v240
    ds_read_b64 v[112:113], v240
    s_add_u32 s39, s53, 18960
    v_add_u32 v240, s39, v251
    v_lshlrev_b32 v240, 3, v240
    ds_read_b64 v[114:115], v240
    s_add_u32 s39, s54, 18960
    v_add_u32 v240, s39, v251
    v_lshlrev_b32 v240, 3, v240
    ds_read_b64 v[116:117], v240
    s_add_u32 s39, s55, 18960
    v_add_u32 v240, s39, v251
    v_lshlrev_b32 v240, 3, v240
    ds_read_b64 v[118:119], v240
    s_lshl_b32 s39, s44, 6
    s_add_u32 s39, s39, 162816
    v_lshl_add_u32 v240, v252, 4, s39
    ds_read_b128 v[144:147], v240
    s_lshl_b32 s39, s45, 6
    s_add_u32 s39, s39, 162816
    v_lshl_add_u32 v240, v252, 4, s39
    ds_read_b128 v[148:151], v240
    s_lshl_b32 s39, s46, 6
    s_add_u32 s39, s39, 162816
    v_lshl_add_u32 v240, v252, 4, s39
    ds_read_b128 v[152:155], v240
    s_lshl_b32 s39, s47, 6
    s_add_u32 s39, s39, 162816
    v_lshl_add_u32 v240, v252, 4, s39
    ds_read_b128 v[156:159], v240
    s_lshl_b32 s39, s48, 6
    s_add_u32 s39, s39, 162816
    v_lshl_add_u32 v240, v252, 4, s39
    ds_read_b128 v[160:163], v240
    s_lshl_b32 s39, s49, 6
    s_add_u32 s39, s39, 162816
    v_lshl_add_u32 v240, v252, 4, s39
    ds_read_b128 v[164:167], v240
    s_waitcnt lgkmcnt(0)
    v_and_b32 v236, 1, v252
    v_lshrrev_b32 v237, 1, v252
    v_lshl_or_b32 v244, v236, 1, v237
    v_mul_u32_u24 v245, 400, v251
    v_lshl_add_u32 v245, v252, 3, v245
    s_add_u32 s39, s52, 16
    s_mul_i32 s43, s39, 400
    v_pk_fma_f32 v[0:1], v[144:145], v[112:113], v[0:1] op_sel_hi:[1,0,1] neg_lo:[0,1,0] neg_hi:[0,1,0]
    v_pk_fma_f32 v[2:3], v[146:147], v[112:113], v[2:3] op_sel_hi:[1,0,1] neg_lo:[0,1,0] neg_hi:[0,1,0]
    v_pk_mul_f32 v[0:1], v[0:1], v[112:113] op_sel:[0,1] op_sel_hi:[1,1]
    v_pk_mul_f32 v[2:3], v[2:3], v[112:113] op_sel:[0,1] op_sel_hi:[1,1]
    v_cvt_pk_bf16_f32 v128, v0, v1
    v_cvt_pk_bf16_f32 v129, v2, v3
    s_lshl_b32 s39, s44, 5
    s_add_u32 s39, s39, s43
    v_add_u32 v236, s39, v245
    ds_write_b64 v236, v[128:129]
    v_pk_fma_f32 v[16:17], v[148:149], v[112:113], v[16:17] op_sel_hi:[1,0,1] neg_lo:[0,1,0] neg_hi:[0,1,0]
    v_pk_fma_f32 v[18:19], v[150:151], v[112:113], v[18:19] op_sel_hi:[1,0,1] neg_lo:[0,1,0] neg_hi:[0,1,0]
    v_pk_mul_f32 v[16:17], v[16:17], v[112:113] op_sel:[0,1] op_sel_hi:[1,1]
    v_pk_mul_f32 v[18:19], v[18:19], v[112:113] op_sel:[0,1] op_sel_hi:[1,1]
    v_cvt_pk_bf16_f32 v130, v16, v17
    v_cvt_pk_bf16_f32 v131, v18, v19
    s_lshl_b32 s39, s45, 5
    s_add_u32 s39, s39, s43
    v_add_u32 v236, s39, v245
    ds_write_b64 v236, v[130:131]
    v_pk_fma_f32 v[32:33], v[152:153], v[112:113], v[32:33] op_sel_hi:[1,0,1] neg_lo:[0,1,0] neg_hi:[0,1,0]
    v_pk_fma_f32 v[34:35], v[154:155], v[112:113], v[34:35] op_sel_hi:[1,0,1] neg_lo:[0,1,0] neg_hi:[0,1,0]
    v_pk_mul_f32 v[32:33], v[32:33], v[112:113] op_sel:[0,1] op_sel_hi:[1,1]
    v_pk_mul_f32 v[34:35], v[34:35], v[112:113] op_sel:[0,1] op_sel_hi:[1,1]
    v_cvt_pk_bf16_f32 v132, v32, v33
    v_cvt_pk_bf16_f32 v133, v34, v35
    s_lshl_b32 s39, s46, 5
    s_add_u32 s39, s39, s43
    v_add_u32 v236, s39, v245
    ds_write_b64 v236, v[132:133]
    v_pk_fma_f32 v[48:49], v[156:157], v[112:113], v[48:49] op_sel_hi:[1,0,1] neg_lo:[0,1,0] neg_hi:[0,1,0]
    v_pk_fma_f32 v[50:51], v[158:159], v[112:113], v[50:51] op_sel_hi:[1,0,1] neg_lo:[0,1,0] neg_hi:[0,1,0]
    v_pk_mul_f32 v[48:49], v[48:49], v[112:113] op_sel:[0,1] op_sel_hi:[1,1]
    v_pk_mul_f32 v[50:51], v[50:51], v[112:113] op_sel:[0,1] op_sel_hi:[1,1]
    v_cvt_pk_bf16_f32 v134, v48, v49
    v_cvt_pk_bf16_f32 v135, v50, v51
    s_lshl_b32 s39, s47, 5
    s_add_u32 s39, s39, s43
    v_add_u32 v236, s39, v245
    ds_write_b64 v236, v[134:135]
    v_pk_fma_f32 v[64:65], v[160:161], v[112:113], v[64:65] op_sel_hi:[1,0,1] neg_lo:[0,1,0] neg_hi:[0,1,0]
    v_pk_fma_f32 v[66:67], v[162:163], v[112:113], v[66:67] op_sel_hi:[1,0,1] neg_lo:[0,1,0] neg_hi:[0,1,0]
    v_pk_mul_f32 v[64:65], v[64:65], v[112:113] op_sel:[0,1] op_sel_hi:[1,1]
    v_pk_mul_f32 v[66:67], v[66:67], v[112:113] op_sel:[0,1] op_sel_hi:[1,1]
    v_cvt_pk_bf16_f32 v136, v64, v65
    v_cvt_pk_bf16_f32 v137, v66, v67
    s_lshl_b32 s39, s48, 5
    s_add_u32 s39, s39, s43
    v_add_u32 v236, s39, v245
    ds_write_b64 v236, v[136:137]
    v_pk_fma_f32 v[80:81], v[164:165], v[112:113], v[80:81] op_sel_hi:[1,0,1] neg_lo:[0,1,0] neg_hi:[0,1,0]
    v_pk_fma_f32 v[82:83], v[166:167], v[112:113], v[82:83] op_sel_hi:[1,0,1] neg_lo:[0,1,0] neg_hi:[0,1,0]
    v_pk_mul_f32 v[80:81], v[80:81], v[112:113] op_sel:[0,1] op_sel_hi:[1,1]
    v_pk_mul_f32 v[82:83], v[82:83], v[112:113] op_sel:[0,1] op_sel_hi:[1,1]
    v_cvt_pk_bf16_f32 v138, v80, v81
    v_cvt_pk_bf16_f32 v139, v82, v83
    s_lshl_b32 s39, s49, 5
    s_add_u32 s39, s39, s43
    v_add_u32 v236, s39, v245
    ds_write_b64 v236, v[138:139]
    s_add_u32 s39, s53, 16
    s_mul_i32 s43, s39, 400
    v_pk_fma_f32 v[4:5], v[144:145], v[114:115], v[4:5] op_sel_hi:[1,0,1] neg_lo:[0,1,0] neg_hi:[0,1,0]
    v_pk_fma_f32 v[6:7], v[146:147], v[114:115], v[6:7] op_sel_hi:[1,0,1] neg_lo:[0,1,0] neg_hi:[0,1,0]
    v_pk_mul_f32 v[4:5], v[4:5], v[114:115] op_sel:[0,1] op_sel_hi:[1,1]
    v_pk_mul_f32 v[6:7], v[6:7], v[114:115] op_sel:[0,1] op_sel_hi:[1,1]
    v_cvt_pk_bf16_f32 v140, v4, v5
    v_cvt_pk_bf16_f32 v141, v6, v7
    s_lshl_b32 s39, s44, 5
    s_add_u32 s39, s39, s43
    v_add_u32 v236, s39, v245
    ds_write_b64 v236, v[140:141]
    v_pk_fma_f32 v[20:21], v[148:149], v[114:115], v[20:21] op_sel_hi:[1,0,1] neg_lo:[0,1,0] neg_hi:[0,1,0]
    v_pk_fma_f32 v[22:23], v[150:151], v[114:115], v[22:23] op_sel_hi:[1,0,1] neg_lo:[0,1,0] neg_hi:[0,1,0]
    v_pk_mul_f32 v[20:21], v[20:21], v[114:115] op_sel:[0,1] op_sel_hi:[1,1]
    v_pk_mul_f32 v[22:23], v[22:23], v[114:115] op_sel:[0,1] op_sel_hi:[1,1]
    v_cvt_pk_bf16_f32 v142, v20, v21
    v_cvt_pk_bf16_f32 v143, v22, v23
    s_lshl_b32 s39, s45, 5
    s_add_u32 s39, s39, s43
    v_add_u32 v236, s39, v245
    ds_write_b64 v236, v[142:143]
    v_pk_fma_f32 v[36:37], v[152:153], v[114:115], v[36:37] op_sel_hi:[1,0,1] neg_lo:[0,1,0] neg_hi:[0,1,0]
    v_pk_fma_f32 v[38:39], v[154:155], v[114:115], v[38:39] op_sel_hi:[1,0,1] neg_lo:[0,1,0] neg_hi:[0,1,0]
    v_pk_mul_f32 v[36:37], v[36:37], v[114:115] op_sel:[0,1] op_sel_hi:[1,1]
    v_pk_mul_f32 v[38:39], v[38:39], v[114:115] op_sel:[0,1] op_sel_hi:[1,1]
    v_cvt_pk_bf16_f32 v128, v36, v37
    v_cvt_pk_bf16_f32 v129, v38, v39
    s_lshl_b32 s39, s46, 5
    s_add_u32 s39, s39, s43
    v_add_u32 v236, s39, v245
    ds_write_b64 v236, v[128:129]
    v_pk_fma_f32 v[52:53], v[156:157], v[114:115], v[52:53] op_sel_hi:[1,0,1] neg_lo:[0,1,0] neg_hi:[0,1,0]
    v_pk_fma_f32 v[54:55], v[158:159], v[114:115], v[54:55] op_sel_hi:[1,0,1] neg_lo:[0,1,0] neg_hi:[0,1,0]
    v_pk_mul_f32 v[52:53], v[52:53], v[114:115] op_sel:[0,1] op_sel_hi:[1,1]
    v_pk_mul_f32 v[54:55], v[54:55], v[114:115] op_sel:[0,1] op_sel_hi:[1,1]
    v_cvt_pk_bf16_f32 v130, v52, v53
    v_cvt_pk_bf16_f32 v131, v54, v55
    s_lshl_b32 s39, s47, 5
    s_add_u32 s39, s39, s43
    v_add_u32 v236, s39, v245
    ds_write_b64 v236, v[130:131]
    v_pk_fma_f32 v[68:69], v[160:161], v[114:115], v[68:69] op_sel_hi:[1,0,1] neg_lo:[0,1,0] neg_hi:[0,1,0]
    v_pk_fma_f32 v[70:71], v[162:163], v[114:115], v[70:71] op_sel_hi:[1,0,1] neg_lo:[0,1,0] neg_hi:[0,1,0]
    v_pk_mul_f32 v[68:69], v[68:69], v[114:115] op_sel:[0,1] op_sel_hi:[1,1]
    v_pk_mul_f32 v[70:71], v[70:71], v[114:115] op_sel:[0,1] op_sel_hi:[1,1]
    v_cvt_pk_bf16_f32 v132, v68, v69
    v_cvt_pk_bf16_f32 v133, v70, v71
    s_lshl_b32 s39, s48, 5
    s_add_u32 s39, s39, s43
    v_add_u32 v236, s39, v245
    ds_write_b64 v236, v[132:133]
    v_pk_fma_f32 v[84:85], v[164:165], v[114:115], v[84:85] op_sel_hi:[1,0,1] neg_lo:[0,1,0] neg_hi:[0,1,0]
    v_pk_fma_f32 v[86:87], v[166:167], v[114:115], v[86:87] op_sel_hi:[1,0,1] neg_lo:[0,1,0] neg_hi:[0,1,0]
    v_pk_mul_f32 v[84:85], v[84:85], v[114:115] op_sel:[0,1] op_sel_hi:[1,1]
    v_pk_mul_f32 v[86:87], v[86:87], v[114:115] op_sel:[0,1] op_sel_hi:[1,1]
    v_cvt_pk_bf16_f32 v134, v84, v85
    v_cvt_pk_bf16_f32 v135, v86, v87
    s_lshl_b32 s39, s49, 5
    s_add_u32 s39, s39, s43
    v_add_u32 v236, s39, v245
    ds_write_b64 v236, v[134:135]
    s_add_u32 s39, s54, 16
    s_mul_i32 s43, s39, 400
    v_pk_fma_f32 v[8:9], v[144:145], v[116:117], v[8:9] op_sel_hi:[1,0,1] neg_lo:[0,1,0] neg_hi:[0,1,0]
    v_pk_fma_f32 v[10:11], v[146:147], v[116:117], v[10:11] op_sel_hi:[1,0,1] neg_lo:[0,1,0] neg_hi:[0,1,0]
    v_pk_mul_f32 v[8:9], v[8:9], v[116:117] op_sel:[0,1] op_sel_hi:[1,1]
    v_pk_mul_f32 v[10:11], v[10:11], v[116:117] op_sel:[0,1] op_sel_hi:[1,1]
    v_cvt_pk_bf16_f32 v136, v8, v9
    v_cvt_pk_bf16_f32 v137, v10, v11
    s_lshl_b32 s39, s44, 5
    s_add_u32 s39, s39, s43
    v_add_u32 v236, s39, v245
    ds_write_b64 v236, v[136:137]
    v_pk_fma_f32 v[24:25], v[148:149], v[116:117], v[24:25] op_sel_hi:[1,0,1] neg_lo:[0,1,0] neg_hi:[0,1,0]
    v_pk_fma_f32 v[26:27], v[150:151], v[116:117], v[26:27] op_sel_hi:[1,0,1] neg_lo:[0,1,0] neg_hi:[0,1,0]
    v_pk_mul_f32 v[24:25], v[24:25], v[116:117] op_sel:[0,1] op_sel_hi:[1,1]
    v_pk_mul_f32 v[26:27], v[26:27], v[116:117] op_sel:[0,1] op_sel_hi:[1,1]
    v_cvt_pk_bf16_f32 v138, v24, v25
    v_cvt_pk_bf16_f32 v139, v26, v27
    s_lshl_b32 s39, s45, 5
    s_add_u32 s39, s39, s43
    v_add_u32 v236, s39, v245
    ds_write_b64 v236, v[138:139]
    v_pk_fma_f32 v[40:41], v[152:153], v[116:117], v[40:41] op_sel_hi:[1,0,1] neg_lo:[0,1,0] neg_hi:[0,1,0]
    v_pk_fma_f32 v[42:43], v[154:155], v[116:117], v[42:43] op_sel_hi:[1,0,1] neg_lo:[0,1,0] neg_hi:[0,1,0]
    v_pk_mul_f32 v[40:41], v[40:41], v[116:117] op_sel:[0,1] op_sel_hi:[1,1]
    v_pk_mul_f32 v[42:43], v[42:43], v[116:117] op_sel:[0,1] op_sel_hi:[1,1]
    v_cvt_pk_bf16_f32 v140, v40, v41
    v_cvt_pk_bf16_f32 v141, v42, v43
    s_lshl_b32 s39, s46, 5
    s_add_u32 s39, s39, s43
    v_add_u32 v236, s39, v245
    ds_write_b64 v236, v[140:141]
    v_pk_fma_f32 v[56:57], v[156:157], v[116:117], v[56:57] op_sel_hi:[1,0,1] neg_lo:[0,1,0] neg_hi:[0,1,0]
    v_pk_fma_f32 v[58:59], v[158:159], v[116:117], v[58:59] op_sel_hi:[1,0,1] neg_lo:[0,1,0] neg_hi:[0,1,0]
    v_pk_mul_f32 v[56:57], v[56:57], v[116:117] op_sel:[0,1] op_sel_hi:[1,1]
    v_pk_mul_f32 v[58:59], v[58:59], v[116:117] op_sel:[0,1] op_sel_hi:[1,1]
    v_cvt_pk_bf16_f32 v142, v56, v57
    v_cvt_pk_bf16_f32 v143, v58, v59
    s_lshl_b32 s39, s47, 5
    s_add_u32 s39, s39, s43
    v_add_u32 v236, s39, v245
    ds_write_b64 v236, v[142:143]
    v_pk_fma_f32 v[72:73], v[160:161], v[116:117], v[72:73] op_sel_hi:[1,0,1] neg_lo:[0,1,0] neg_hi:[0,1,0]
    v_pk_fma_f32 v[74:75], v[162:163], v[116:117], v[74:75] op_sel_hi:[1,0,1] neg_lo:[0,1,0] neg_hi:[0,1,0]
    v_pk_mul_f32 v[72:73], v[72:73], v[116:117] op_sel:[0,1] op_sel_hi:[1,1]
    v_pk_mul_f32 v[74:75], v[74:75], v[116:117] op_sel:[0,1] op_sel_hi:[1,1]
    v_cvt_pk_bf16_f32 v128, v72, v73
    v_cvt_pk_bf16_f32 v129, v74, v75
    s_lshl_b32 s39, s48, 5
    s_add_u32 s39, s39, s43
    v_add_u32 v236, s39, v245
    ds_write_b64 v236, v[128:129]
    v_pk_fma_f32 v[88:89], v[164:165], v[116:117], v[88:89] op_sel_hi:[1,0,1] neg_lo:[0,1,0] neg_hi:[0,1,0]
    v_pk_fma_f32 v[90:91], v[166:167], v[116:117], v[90:91] op_sel_hi:[1,0,1] neg_lo:[0,1,0] neg_hi:[0,1,0]
    v_pk_mul_f32 v[88:89], v[88:89], v[116:117] op_sel:[0,1] op_sel_hi:[1,1]
    v_pk_mul_f32 v[90:91], v[90:91], v[116:117] op_sel:[0,1] op_sel_hi:[1,1]
    v_cvt_pk_bf16_f32 v130, v88, v89
    v_cvt_pk_bf16_f32 v131, v90, v91
    s_lshl_b32 s39, s49, 5
    s_add_u32 s39, s39, s43
    v_add_u32 v236, s39, v245
    ds_write_b64 v236, v[130:131]
    s_add_u32 s39, s55, 16
    s_mul_i32 s43, s39, 400
    v_pk_fma_f32 v[12:13], v[144:145], v[118:119], v[12:13] op_sel_hi:[1,0,1] neg_lo:[0,1,0] neg_hi:[0,1,0]
    v_pk_fma_f32 v[14:15], v[146:147], v[118:119], v[14:15] op_sel_hi:[1,0,1] neg_lo:[0,1,0] neg_hi:[0,1,0]
    v_pk_mul_f32 v[12:13], v[12:13], v[118:119] op_sel:[0,1] op_sel_hi:[1,1]
    v_pk_mul_f32 v[14:15], v[14:15], v[118:119] op_sel:[0,1] op_sel_hi:[1,1]
    v_cvt_pk_bf16_f32 v132, v12, v13
    v_cvt_pk_bf16_f32 v133, v14, v15
    s_lshl_b32 s39, s44, 5
    s_add_u32 s39, s39, s43
    v_add_u32 v236, s39, v245
    ds_write_b64 v236, v[132:133]
    v_pk_fma_f32 v[28:29], v[148:149], v[118:119], v[28:29] op_sel_hi:[1,0,1] neg_lo:[0,1,0] neg_hi:[0,1,0]
    v_pk_fma_f32 v[30:31], v[150:151], v[118:119], v[30:31] op_sel_hi:[1,0,1] neg_lo:[0,1,0] neg_hi:[0,1,0]
    v_pk_mul_f32 v[28:29], v[28:29], v[118:119] op_sel:[0,1] op_sel_hi:[1,1]
    v_pk_mul_f32 v[30:31], v[30:31], v[118:119] op_sel:[0,1] op_sel_hi:[1,1]
    v_cvt_pk_bf16_f32 v134, v28, v29
    v_cvt_pk_bf16_f32 v135, v30, v31
    s_lshl_b32 s39, s45, 5
    s_add_u32 s39, s39, s43
    v_add_u32 v236, s39, v245
    ds_write_b64 v236, v[134:135]
    v_pk_fma_f32 v[44:45], v[152:153], v[118:119], v[44:45] op_sel_hi:[1,0,1] neg_lo:[0,1,0] neg_hi:[0,1,0]
    v_pk_fma_f32 v[46:47], v[154:155], v[118:119], v[46:47] op_sel_hi:[1,0,1] neg_lo:[0,1,0] neg_hi:[0,1,0]
    v_pk_mul_f32 v[44:45], v[44:45], v[118:119] op_sel:[0,1] op_sel_hi:[1,1]
    v_pk_mul_f32 v[46:47], v[46:47], v[118:119] op_sel:[0,1] op_sel_hi:[1,1]
    v_cvt_pk_bf16_f32 v136, v44, v45
    v_cvt_pk_bf16_f32 v137, v46, v47
    s_lshl_b32 s39, s46, 5
    s_add_u32 s39, s39, s43
    v_add_u32 v236, s39, v245
    ds_write_b64 v236, v[136:137]
    v_pk_fma_f32 v[60:61], v[156:157], v[118:119], v[60:61] op_sel_hi:[1,0,1] neg_lo:[0,1,0] neg_hi:[0,1,0]
    v_pk_fma_f32 v[62:63], v[158:159], v[118:119], v[62:63] op_sel_hi:[1,0,1] neg_lo:[0,1,0] neg_hi:[0,1,0]
    v_pk_mul_f32 v[60:61], v[60:61], v[118:119] op_sel:[0,1] op_sel_hi:[1,1]
    v_pk_mul_f32 v[62:63], v[62:63], v[118:119] op_sel:[0,1] op_sel_hi:[1,1]
    v_cvt_pk_bf16_f32 v138, v60, v61
    v_cvt_pk_bf16_f32 v139, v62, v63
    s_lshl_b32 s39, s47, 5
    s_add_u32 s39, s39, s43
    v_add_u32 v236, s39, v245
    ds_write_b64 v236, v[138:139]
    v_pk_fma_f32 v[76:77], v[160:161], v[118:119], v[76:77] op_sel_hi:[1,0,1] neg_lo:[0,1,0] neg_hi:[0,1,0]
    v_pk_fma_f32 v[78:79], v[162:163], v[118:119], v[78:79] op_sel_hi:[1,0,1] neg_lo:[0,1,0] neg_hi:[0,1,0]
    v_pk_mul_f32 v[76:77], v[76:77], v[118:119] op_sel:[0,1] op_sel_hi:[1,1]
    v_pk_mul_f32 v[78:79], v[78:79], v[118:119] op_sel:[0,1] op_sel_hi:[1,1]
    v_cvt_pk_bf16_f32 v140, v76, v77
    v_cvt_pk_bf16_f32 v141, v78, v79
    s_lshl_b32 s39, s48, 5
    s_add_u32 s39, s39, s43
    v_add_u32 v236, s39, v245
    ds_write_b64 v236, v[140:141]
    v_pk_fma_f32 v[92:93], v[164:165], v[118:119], v[92:93] op_sel_hi:[1,0,1] neg_lo:[0,1,0] neg_hi:[0,1,0]
    v_pk_fma_f32 v[94:95], v[166:167], v[118:119], v[94:95] op_sel_hi:[1,0,1] neg_lo:[0,1,0] neg_hi:[0,1,0]
    v_pk_mul_f32 v[92:93], v[92:93], v[118:119] op_sel:[0,1] op_sel_hi:[1,1]
    v_pk_mul_f32 v[94:95], v[94:95], v[118:119] op_sel:[0,1] op_sel_hi:[1,1]
    v_cvt_pk_bf16_f32 v142, v92, v93
    v_cvt_pk_bf16_f32 v143, v94, v95
    s_lshl_b32 s39, s49, 5
    s_add_u32 s39, s39, s43
    v_add_u32 v236, s39, v245
    ds_write_b64 v236, v[142:143]
    s_waitcnt lgkmcnt(0)
    s_barrier
    s_branch g1_attn
g1_10:
    s_mov_b32 s16, s10
    s_and_b32 s17, s11, 0xffff
    s_mov_b32 s18, 7340032
    s_mov_b32 s19, 0x20000
    v_lshrrev_b32 v236, 3, v250
    v_and_b32 v237, 7, v250
    v_xor_b32 v237, v237, v236
    s_lshl_b32 s39, s29, 8
    s_lshl_b32 s42, s28, 5
    s_add_u32 s39, s39, s42
    s_add_u32 s39, s39, 128
    v_add_u32 v238, s39, v236
    v_lshlrev_b32 v238, 11, v238
    v_lshl_add_u32 v230, v237, 4, v238
    s_mul_i32 s43, s28, 256
    s_add_u32 s39, s43, 0
    v_add_u32 v236, s39, v250
    v_mul_u32_u24 v237, 2341, v236
    v_lshrrev_b32 v237, 16, v237
    v_mul_u32_u24 v238, 28, v237
    v_sub_u32 v238, v236, v238
    v_bfe_u32 v239, v237, 3, 1
    v_lshlrev_b32 v239, 1, v239
    v_xor_b32 v238, v238, v239
    v_lshlrev_b32 v238, 4, v238
    s_mul_i32 s39, s30, 448
    v_add_u32 v238, s39, v238
    v_mul_u32_u24 v237, 7168, v237
    v_add_u32 v231, v237, v238
    s_add_u32 s39, s43, 64
    v_add_u32 v236, s39, v250
    v_mul_u32_u24 v237, 2341, v236
    v_lshrrev_b32 v237, 16, v237
    v_mul_u32_u24 v238, 28, v237
    v_sub_u32 v238, v236, v238
    v_bfe_u32 v239, v237, 3, 1
    v_lshlrev_b32 v239, 1, v239
    v_xor_b32 v238, v238, v239
    v_lshlrev_b32 v238, 4, v238
    s_mul_i32 s39, s30, 448
    v_add_u32 v238, s39, v238
    v_mul_u32_u24 v237, 7168, v237
    v_add_u32 v232, v237, v238
    s_add_u32 s39, s43, 128
    v_add_u32 v236, s39, v250
    v_mul_u32_u24 v237, 2341, v236
    v_lshrrev_b32 v237, 16, v237
    v_mul_u32_u24 v238, 28, v237
    v_sub_u32 v238, v236, v238
    v_bfe_u32 v239, v237, 3, 1
    v_lshlrev_b32 v239, 1, v239
    v_xor_b32 v238, v238, v239
    v_lshlrev_b32 v238, 4, v238
    s_mul_i32 s39, s30, 448
    v_add_u32 v238, s39, v238
    v_mul_u32_u24 v237, 7168, v237
    v_add_u32 v233, v237, v238
    s_add_u32 s39, s43, 192
    v_add_u32 v236, s39, v250
    v_mul_u32_u24 v237, 2341, v236
    v_lshrrev_b32 v237, 16, v237
    v_mul_u32_u24 v238, 28, v237
    v_sub_u32 v238, v236, v238
    v_bfe_u32 v239, v237, 3, 1
    v_lshlrev_b32 v239, 1, v239
    v_xor_b32 v238, v238, v239
    v_lshlrev_b32 v238, 4, v238
    s_mul_i32 s39, s30, 448
    v_add_u32 v238, s39, v238
    v_mul_u32_u24 v237, 7168, v237
    v_add_u32 v234, v237, v238
    s_lshl_b32 s32, s29, 8
    s_and_b32 s32, s32, 0x7ff
    s_mul_i32 s33, s29, 917504
    s_mov_b32 s41, s32
    s_lshl_b32 s34, s28, 12
    s_add_u32 s34, s34, 32768
    s_mul_i32 s35, s28, 4096
    s_add_u32 s35, s35, 65536
    s_mov_b32 s37, 0
    s_add_u32 m0, s35, 0
    s_nop 0
    buffer_load_dwordx4 v231, s[16:19], s33 offen lds
    s_add_u32 m0, s35, 1024
    s_nop 0
    buffer_load_dwordx4 v232, s[16:19], s33 offen lds
    s_add_u32 m0, s35, 2048
    s_nop 0
    buffer_load_dwordx4 v233, s[16:19], s33 offen lds
    s_add_u32 m0, s35, 3072
    s_nop 0
    buffer_load_dwordx4 v234, s[16:19], s33 offen lds
    s_add_u32 s33, s33, 458752
    s_cmp_eq_u32 s33, 7340032
    s_cselect_b32 s33, 0, s33
    s_add_u32 s37, s37, 1
    s_add_u32 s35, s35, 28672
    s_cmp_eq_u32 s37, 3
    s_cselect_b32 s39, 86016, 0
    s_cselect_b32 s37, 0, s37
    s_sub_u32 s35, s35, s39
    s_add_u32 m0, s34, 0
    s_add_u32 s39, s32, 0
    buffer_load_dwordx4 v230, s[96:99], s39 offen lds
    s_add_u32 m0, s34, 1024
    s_add_u32 s39, s32, 16384
    buffer_load_dwordx4 v230, s[96:99], s39 offen lds
    s_add_u32 m0, s34, 2048
    s_add_u32 s39, s32, 32768
    buffer_load_dwordx4 v230, s[96:99], s39 offen lds
    s_add_u32 m0, s34, 3072
    s_add_u32 s39, s32, 49152
    buffer_load_dwordx4 v230, s[96:99], s39 offen lds
    s_add_u32 s32, s32, 128
    s_and_b32 s32, s32, 0x7ff
    s_xor_b32 s34, s34, 16384
    s_add_u32 m0, s35, 0
    s_nop 0
    buffer_load_dwordx4 v231, s[16:19], s33 offen lds
    s_add_u32 m0, s35, 1024
    s_nop 0
    buffer_load_dwordx4 v232, s[16:19], s33 offen lds
    s_add_u32 m0, s35, 2048
    s_nop 0
    buffer_load_dwordx4 v233, s[16:19], s33 offen lds
    s_add_u32 m0, s35, 3072
    s_nop 0
    buffer_load_dwordx4 v234, s[16:19], s33 offen lds
    s_add_u32 s33, s33, 458752
    s_cmp_eq_u32 s33, 7340032
    s_cselect_b32 s33, 0, s33
    s_add_u32 s37, s37, 1
    s_add_u32 s35, s35, 28672
    s_cmp_eq_u32 s37, 3
    s_cselect_b32 s39, 86016, 0
    s_cselect_b32 s37, 0, s37
    s_sub_u32 s35, s35, s39
    s_and_b32 s93, s93, 0xffff
    s_and_b32 s95, s95, 0xffff
    s_lshl_b32 s70, s2, 3
    s_add_u32 s70, s70, s24
    s_lshl_b32 s70, s70, 10
    v_lshlrev_b32 v216, 4, v250
    s_mov_b32 s71, 917504
    s_mov_b32 s91, 0
    s_add_u32 s64, s8, 29360128
    s_addc_u32 s65, s9, 0
    s_and_b32 s65, s65, 0xffff
    s_mov_b32 s66, 327680
    s_mov_b32 s67, 0x20000
    s_mov_b32 s72, s78
    s_and_b32 s73, s79, 0xffff
    s_mov_b32 s74, 256
    s_mov_b32 s75, 0x20000
    s_add_u32 s76, s30, 16
    s_mov_b32 s77, 53284
    s_lshl_b32 s42, s27, 3
    s_add_u32 s39, s26, 0
    s_cmp_ge_u32 s39, 3
    s_cselect_b32 s43, 3, 0
    s_sub_u32 s39, s39, s43
    s_lshl_b32 s39, s39, 1
    s_add_u32 s44, s39, s42
    s_add_u32 s45, s44, 1
    s_add_u32 s39, s26, 1
    s_cmp_ge_u32 s39, 3
    s_cselect_b32 s43, 3, 0
    s_sub_u32 s39, s39, s43
    s_lshl_b32 s39, s39, 1
    s_add_u32 s46, s39, s42
    s_add_u32 s47, s46, 1
    s_add_u32 s39, s26, 2
    s_cmp_ge_u32 s39, 3
    s_cselect_b32 s43, 3, 0
    s_sub_u32 s39, s39, s43
    s_lshl_b32 s39, s39, 1
    s_add_u32 s48, s39, s42
    s_add_u32 s49, s48, 1
    s_add_u32 s50, s27, 6
    v_and_b32 v236, 7, v251
    v_xor_b32 v236, v252, v236
    v_lshlrev_b32 v236, 4, v236
    v_lshl_add_u32 v236, v251, 7, v236
    s_lshl_b32 s39, s26, 13
    s_add_u32 s39, s39, 0
    s_lshl_b32 s42, s27, 12
    s_add_u32 s43, s39, s42
    v_add_u32 v217, s43, v236
    v_xor_b32 v218, 64, v217
    s_xor_b32 s42, s42, 4096
    s_add_u32 s43, s39, s42
    v_add_u32 v219, s43, v236
    v_xor_b32 v220, 64, v219
    v_lshrrev_b32 v236, 2, v251
    v_lshl_add_u32 v237, v252, 3, v236
    v_mul_u32_u24 v237, 448, v237
    v_and_b32 v238, 3, v250
    v_lshl_add_u32 v237, v238, 3, v237
    v_add_u32 v237, 65536, v237
    v_and_b32 v238, 1, v252
    v_xor_b32 v239, s44, v238
    v_lshl_add_u32 v221, v239, 5, v237
    v_xor_b32 v239, s45, v238
    v_lshl_add_u32 v222, v239, 5, v237
    v_xor_b32 v239, s46, v238
    v_lshl_add_u32 v223, v239, 5, v237
    v_xor_b32 v239, s47, v238
    v_lshl_add_u32 v224, v239, 5, v237
    v_xor_b32 v239, s48, v238
    v_lshl_add_u32 v225, v239, 5, v237
    v_xor_b32 v239, s49, v238
    v_lshl_add_u32 v226, v239, 5, v237
    v_xor_b32 v239, s50, v238
    v_lshl_add_u32 v227, v239, 5, v237
    v_mov_b32 v0, 0
    v_mov_b32 v1, 0
    v_mov_b32 v2, 0
    v_mov_b32 v3, 0
    v_mov_b32 v4, 0
    v_mov_b32 v5, 0
    v_mov_b32 v6, 0
    v_mov_b32 v7, 0
    v_mov_b32 v8, 0
    v_mov_b32 v9, 0
    v_mov_b32 v10, 0
    v_mov_b32 v11, 0
    v_mov_b32 v12, 0
    v_mov_b32 v13, 0
    v_mov_b32 v14, 0
    v_mov_b32 v15, 0
    v_mov_b32 v16, 0
    v_mov_b32 v17, 0
    v_mov_b32 v18, 0
    v_mov_b32 v19, 0
    v_mov_b32 v20, 0
    v_mov_b32 v21, 0
    v_mov_b32 v22, 0
    v_mov_b32 v23, 0
    v_mov_b32 v24, 0
    v_mov_b32 v25, 0
    v_mov_b32 v26, 0
    v_mov_b32 v27, 0
    v_mov_b32 v28, 0
    v_mov_b32 v29, 0
    v_mov_b32 v30, 0
    v_mov_b32 v31, 0
    v_mov_b32 v32, 0
    v_mov_b32 v33, 0
    v_mov_b32 v34, 0
    v_mov_b32 v35, 0
    v_mov_b32 v36, 0
    v_mov_b32 v37, 0
    v_mov_b32 v38, 0
    v_mov_b32 v39, 0
    v_mov_b32 v40, 0
    v_mov_b32 v41, 0
    v_mov_b32 v42, 0
    v_mov_b32 v43, 0
    v_mov_b32 v44, 0
    v_mov_b32 v45, 0
    v_mov_b32 v46, 0
    v_mov_b32 v47, 0
    v_mov_b32 v48, 0
    v_mov_b32 v49, 0
    v_mov_b32 v50, 0
    v_mov_b32 v51, 0
    v_mov_b32 v52, 0
    v_mov_b32 v53, 0
    v_mov_b32 v54, 0
    v_mov_b32 v55, 0
    v_mov_b32 v56, 0
    v_mov_b32 v57, 0
    v_mov_b32 v58, 0
    v_mov_b32 v59, 0
    v_mov_b32 v60, 0
    v_mov_b32 v61, 0
    v_mov_b32 v62, 0
    v_mov_b32 v63, 0
    v_mov_b32 v64, 0
    v_mov_b32 v65, 0
    v_mov_b32 v66, 0
    v_mov_b32 v67, 0
    v_mov_b32 v68, 0
    v_mov_b32 v69, 0
    v_mov_b32 v70, 0
    v_mov_b32 v71, 0
    v_mov_b32 v72, 0
    v_mov_b32 v73, 0
    v_mov_b32 v74, 0
    v_mov_b32 v75, 0
    v_mov_b32 v76, 0
    v_mov_b32 v77, 0
    v_mov_b32 v78, 0
    v_mov_b32 v79, 0
    v_mov_b32 v80, 0
    v_mov_b32 v81, 0
    v_mov_b32 v82, 0
    v_mov_b32 v83, 0
    v_mov_b32 v84, 0
    v_mov_b32 v85, 0
    v_mov_b32 v86, 0
    v_mov_b32 v87, 0
    v_mov_b32 v88, 0
    v_mov_b32 v89, 0
    v_mov_b32 v90, 0
    v_mov_b32 v91, 0
    v_mov_b32 v92, 0
    v_mov_b32 v93, 0
    v_mov_b32 v94, 0
    v_mov_b32 v95, 0
    v_mov_b32 v96, 0
    v_mov_b32 v97, 0
    v_mov_b32 v98, 0
    v_mov_b32 v99, 0
    v_mov_b32 v100, 0
    v_mov_b32 v101, 0
    v_mov_b32 v102, 0
    v_mov_b32 v103, 0
    v_mov_b32 v104, 0
    v_mov_b32 v105, 0
    v_mov_b32 v106, 0
    v_mov_b32 v107, 0
    v_mov_b32 v108, 0
    v_mov_b32 v109, 0
    v_mov_b32 v110, 0
    v_mov_b32 v111, 0
    v_mov_b32 v208, 0
    v_mov_b32 v209, 0
    v_mov_b32 v210, 0
    v_mov_b32 v211, 0
    v_mov_b32 v212, 0
    v_mov_b32 v213, 0
    v_mov_b32 v214, 0
    v_mov_b32 v215, 0
    v_mov_b32 v240, 0x3f803f80
    v_mov_b32 v241, 0x3f803f80
    v_mov_b32 v242, 0x3f803f80
    v_mov_b32 v243, 0x3f803f80
    s_mov_b32 s60, 28672
    s_mov_b32 s31, 0
    s_mov_b32 s38, 0
    s_waitcnt vmcnt(8)
    s_barrier
    s_mov_b32 s25, s34
    s_mov_b32 s3, s35
.p2align 6
g1_10_loop:
    ds_read_b128 v[112:115], v217 offset:0
    ds_read_b128 v[120:123], v217 offset:2048
    s_add_u32 m0, s25, 0
    s_add_u32 s39, s32, 0
    buffer_load_dwordx4 v230, s[96:99], s39 offen lds
    ds_read_b128 v[128:131], v219 offset:0
    ds_read_b128 v[136:139], v219 offset:2048
    ds_read_b64_tr_b16 v[144:145], v221 offset:0
    ds_read_b64_tr_b16 v[146:147], v221 offset:1792
    s_add_u32 m0, s25, 1024
    s_add_u32 s39, s32, 16384
    buffer_load_dwordx4 v230, s[96:99], s39 offen lds
    ds_read_b64_tr_b16 v[152:153], v222 offset:0
    ds_read_b64_tr_b16 v[154:155], v222 offset:1792
    ds_read_b64_tr_b16 v[160:161], v223 offset:0
    ds_read_b64_tr_b16 v[162:163], v223 offset:1792
    s_add_u32 m0, s25, 2048
    s_add_u32 s39, s32, 32768
    buffer_load_dwordx4 v230, s[96:99], s39 offen lds
    ds_read_b64_tr_b16 v[168:169], v224 offset:0
    ds_read_b64_tr_b16 v[170:171], v224 offset:1792
    ds_read_b64_tr_b16 v[176:177], v225 offset:0
    ds_read_b64_tr_b16 v[178:179], v225 offset:1792
    s_add_u32 m0, s25, 3072
    s_add_u32 s39, s32, 49152
    buffer_load_dwordx4 v230, s[96:99], s39 offen lds
    ds_read_b64_tr_b16 v[184:185], v226 offset:0
    ds_read_b64_tr_b16 v[186:187], v226 offset:1792
    ds_read_b64_tr_b16 v[192:193], v227 offset:0
    ds_read_b64_tr_b16 v[194:195], v227 offset:1792
    s_add_u32 m0, s3, 0
    s_nop 0
    buffer_load_dwordx4 v231, s[16:19], s33 offen lds
    ds_read_b128 v[116:119], v218 offset:0
    ds_read_b128 v[124:127], v218 offset:2048
    ds_read_b128 v[132:135], v220 offset:0
    ds_read_b128 v[140:143], v220 offset:2048
    s_add_u32 m0, s3, 1024
    s_nop 0
    buffer_load_dwordx4 v232, s[16:19], s33 offen lds
    ds_read_b64_tr_b16 v[148:149], v221 offset:14336
    ds_read_b64_tr_b16 v[150:151], v221 offset:16128
    ds_read_b64_tr_b16 v[156:157], v222 offset:14336
    ds_read_b64_tr_b16 v[158:159], v222 offset:16128
    s_add_u32 m0, s3, 2048
    s_nop 0
    buffer_load_dwordx4 v233, s[16:19], s33 offen lds
    ds_read_b64_tr_b16 v[164:165], v223 offset:14336
    ds_read_b64_tr_b16 v[166:167], v223 offset:16128
    ds_read_b64_tr_b16 v[172:173], v224 offset:14336
    ds_read_b64_tr_b16 v[174:175], v224 offset:16128
    s_add_u32 m0, s3, 3072
    s_nop 0
    buffer_load_dwordx4 v234, s[16:19], s33 offen lds
    ds_read_b64_tr_b16 v[180:181], v225 offset:14336
    ds_read_b64_tr_b16 v[182:183], v225 offset:16128
    ds_read_b64_tr_b16 v[188:189], v226 offset:14336
    ds_read_b64_tr_b16 v[190:191], v226 offset:16128
    ds_read_b64_tr_b16 v[196:197], v227 offset:14336
    ds_read_b64_tr_b16 v[198:199], v227 offset:16128
    s_bitcmp1_b32 s77, s31
    s_cbranch_scc1 g1_10_event
    s_waitcnt vmcnt(8) lgkmcnt(0)
g1_10_afterwait:
    s_barrier
    s_setprio 1
    v_mfma_f32_16x16x32_bf16 v[0:3], v[144:147], v[112:115], v[0:3]
    v_mfma_f32_16x16x32_bf16 v[4:7], v[144:147], v[120:123], v[4:7]
    v_mfma_f32_16x16x32_bf16 v[8:11], v[144:147], v[128:131], v[8:11]
    s_add_u32 s32, s32, 128
    v_mfma_f32_16x16x32_bf16 v[12:15], v[144:147], v[136:139], v[12:15]
    s_and_b32 s32, s32, 0x7ff
    v_mfma_f32_16x16x32_bf16 v[16:19], v[152:155], v[112:115], v[16:19]
    s_xor_b32 s34, s34, 16384
    v_mfma_f32_16x16x32_bf16 v[20:23], v[152:155], v[120:123], v[20:23]
    s_cmp_ge_u32 s31, 14
    v_mfma_f32_16x16x32_bf16 v[24:27], v[152:155], v[128:131], v[24:27]
    s_cselect_b32 s98, 0, s98
    v_mfma_f32_16x16x32_bf16 v[28:31], v[152:155], v[136:139], v[28:31]
    s_cselect_b32 s25, 163840, s34
    v_mfma_f32_16x16x32_bf16 v[32:35], v[160:163], v[112:115], v[32:35]
    s_add_u32 s41, s41, 128
    v_mfma_f32_16x16x32_bf16 v[36:39], v[160:163], v[120:123], v[36:39]
    s_and_b32 s41, s41, 0x7ff
    v_mfma_f32_16x16x32_bf16 v[40:43], v[160:163], v[128:131], v[40:43]
    s_add_u32 s91, s91, s71
    v_mfma_f32_16x16x32_bf16 v[44:47], v[160:163], v[136:139], v[44:47]
    s_add_u32 s33, s33, 458752
    v_mfma_f32_16x16x32_bf16 v[48:51], v[168:171], v[112:115], v[48:51]
    s_cmp_eq_u32 s33, 7340032
    v_mfma_f32_16x16x32_bf16 v[52:55], v[168:171], v[120:123], v[52:55]
    s_cselect_b32 s33, 0, s33
    v_mfma_f32_16x16x32_bf16 v[56:59], v[168:171], v[128:131], v[56:59]
    s_add_u32 s37, s37, 1
    v_mfma_f32_16x16x32_bf16 v[60:63], v[168:171], v[136:139], v[60:63]
    s_add_u32 s35, s35, 28672
    v_mfma_f32_16x16x32_bf16 v[64:67], v[176:179], v[112:115], v[64:67]
    s_cmp_eq_u32 s37, 3
    v_mfma_f32_16x16x32_bf16 v[68:71], v[176:179], v[120:123], v[68:71]
    s_cselect_b32 s39, 86016, 0
    v_mfma_f32_16x16x32_bf16 v[72:75], v[176:179], v[128:131], v[72:75]
    s_cselect_b32 s37, 0, s37
    v_mfma_f32_16x16x32_bf16 v[76:79], v[176:179], v[136:139], v[76:79]
    s_sub_u32 s35, s35, s39
    v_mfma_f32_16x16x32_bf16 v[80:83], v[184:187], v[112:115], v[80:83]
    s_cmp_ge_u32 s31, 13
    v_mfma_f32_16x16x32_bf16 v[84:87], v[184:187], v[120:123], v[84:87]
    s_cselect_b32 s3, 163840, s35
    v_mfma_f32_16x16x32_bf16 v[88:91], v[184:187], v[128:131], v[88:91]
    s_cselect_b32 s18, 0, s18
    v_mfma_f32_16x16x32_bf16 v[92:95], v[184:187], v[136:139], v[92:95]
    s_cselect_b32 s14, 0, s14
    v_mfma_f32_16x16x32_bf16 v[96:99], v[192:195], v[112:115], v[96:99]
    s_add_u32 s38, s38, 1
    v_mfma_f32_16x16x32_bf16 v[100:103], v[192:195], v[120:123], v[100:103]
    s_cmp_eq_u32 s38, 3
    v_mfma_f32_16x16x32_bf16 v[104:107], v[192:195], v[128:131], v[104:107]
    s_cselect_b32 s36, 4294909952, s60
    v_mfma_f32_16x16x32_bf16 v[108:111], v[192:195], v[136:139], v[108:111]
    s_cselect_b32 s38, 0, s38
    v_mfma_f32_16x16x32_bf16 v[0:3], v[148:151], v[116:119], v[0:3]
    v_xor_b32 v217, 16384, v217
    v_mfma_f32_16x16x32_bf16 v[4:7], v[148:151], v[124:127], v[4:7]
    v_xor_b32 v218, 16384, v218
    v_mfma_f32_16x16x32_bf16 v[8:11], v[148:151], v[132:135], v[8:11]
    v_xor_b32 v219, 16384, v219
    v_mfma_f32_16x16x32_bf16 v[12:15], v[148:151], v[140:143], v[12:15]
    v_xor_b32 v220, 16384, v220
    v_mfma_f32_16x16x32_bf16 v[16:19], v[156:159], v[116:119], v[16:19]
    v_add_u32 v221, s36, v221
    v_mfma_f32_16x16x32_bf16 v[20:23], v[156:159], v[124:127], v[20:23]
    v_add_u32 v222, s36, v222
    v_mfma_f32_16x16x32_bf16 v[24:27], v[156:159], v[132:135], v[24:27]
    v_add_u32 v223, s36, v223
    v_mfma_f32_16x16x32_bf16 v[28:31], v[156:159], v[140:143], v[28:31]
    v_add_u32 v224, s36, v224
    v_mfma_f32_16x16x32_bf16 v[32:35], v[164:167], v[116:119], v[32:35]
    v_add_u32 v225, s36, v225
    v_mfma_f32_16x16x32_bf16 v[36:39], v[164:167], v[124:127], v[36:39]
    v_add_u32 v226, s36, v226
    v_mfma_f32_16x16x32_bf16 v[40:43], v[164:167], v[132:135], v[40:43]
    v_add_u32 v227, s36, v227
    v_mfma_f32_16x16x32_bf16 v[44:47], v[164:167], v[140:143], v[44:47]
    v_mfma_f32_16x16x32_bf16 v[48:51], v[172:175], v[116:119], v[48:51]
    v_mfma_f32_16x16x32_bf16 v[52:55], v[172:175], v[124:127], v[52:55]
    v_mfma_f32_16x16x32_bf16 v[56:59], v[172:175], v[132:135], v[56:59]
    v_mfma_f32_16x16x32_bf16 v[60:63], v[172:175], v[140:143], v[60:63]
    v_mfma_f32_16x16x32_bf16 v[64:67], v[180:183], v[116:119], v[64:67]
    v_mfma_f32_16x16x32_bf16 v[68:71], v[180:183], v[124:127], v[68:71]
    v_mfma_f32_16x16x32_bf16 v[72:75], v[180:183], v[132:135], v[72:75]
    v_mfma_f32_16x16x32_bf16 v[76:79], v[180:183], v[140:143], v[76:79]
    v_mfma_f32_16x16x32_bf16 v[80:83], v[188:191], v[116:119], v[80:83]
    v_mfma_f32_16x16x32_bf16 v[84:87], v[188:191], v[124:127], v[84:87]
    v_mfma_f32_16x16x32_bf16 v[88:91], v[188:191], v[132:135], v[88:91]
    v_mfma_f32_16x16x32_bf16 v[92:95], v[188:191], v[140:143], v[92:95]
    v_mfma_f32_16x16x32_bf16 v[96:99], v[196:199], v[116:119], v[96:99]
    v_mfma_f32_16x16x32_bf16 v[100:103], v[196:199], v[124:127], v[100:103]
    v_mfma_f32_16x16x32_bf16 v[104:107], v[196:199], v[132:135], v[104:107]
    v_mfma_f32_16x16x32_bf16 v[108:111], v[196:199], v[140:143], v[108:111]
    s_cmp_lt_u32 s31, 2
    s_cbranch_scc0 g1_10_nocs
    v_mfma_f32_16x16x32_bf16 v[208:211], v[144:147], v[240:243], v[208:211]
    v_mfma_f32_16x16x32_bf16 v[212:215], v[152:155], v[240:243], v[212:215]
    v_mfma_f32_16x16x32_bf16 v[208:211], v[148:151], v[240:243], v[208:211]
    v_mfma_f32_16x16x32_bf16 v[212:215], v[156:159], v[240:243], v[212:215]
g1_10_nocs:
    s_setprio 0
    s_add_u32 s31, s31, 1
    s_cmp_lt_u32 s31, 16
    s_barrier
    s_cbranch_scc1 g1_10_loop
    s_branch g1_10_post
g1_10_event:
    s_cmp_eq_u32 s31, 15
    s_cbranch_scc0 g1_10_evn15
    s_waitcnt vmcnt(13) lgkmcnt(0)
    s_branch g1_10_afterwait
g1_10_evn15:
g1_10_ev2:
    s_cmp_eq_u32 s31, 2
    s_cbranch_scc0 g1_10_ev5
    v_lshlrev_b32 v236, 24, v251
    v_lshl_add_u32 v236, v252, 4, v236
    s_lshl_b32 s42, s76, 3
    s_add_u32 s42, s42, s29
    s_lshl_b32 s42, s42, 10
    s_add_u32 s42, s42, 65536
    s_lshl_b32 s39, s44, 6
    s_add_u32 s39, s39, s42
    buffer_store_dwordx4 v[208:211], v236, s[64:67], s39 offen sc0 sc1
    s_lshl_b32 s39, s45, 6
    s_add_u32 s39, s39, s42
    buffer_store_dwordx4 v[212:215], v236, s[64:67], s39 offen sc0 sc1
    s_waitcnt vmcnt(10) lgkmcnt(0)
    s_branch g1_10_afterwait
g1_10_ev5:
    s_cmp_eq_u32 s31, 14
    s_cbranch_scc1 g1_10_ev14
    s_sub_u32 s39, s29, 1
    s_max_i32 s39, s39, 0
    s_lshl_b32 s39, s39, 2
    s_lshl_b32 s42, s76, 2
    s_add_u32 s42, s42, 32
    s_lshl_b32 s43, s29, 2
    v_mov_b32 v236, 0x1000
    v_writelane_b32 v236, s43, 0
    v_writelane_b32 v236, s42, 1
    s_cmp_lg_u32 s24, 0
    s_cselect_b32 s42, 0x1000, 0
    s_cmp_eq_u32 s31, 5
    s_cbranch_scc0 g1_10_ev12
    v_mov_b32 v237, 1
    buffer_atomic_add v237, v236, s[72:75], s42 offen sc1
    s_waitcnt vmcnt(9) lgkmcnt(0)
    s_branch g1_10_afterwait
g1_10_ev12:
    v_writelane_b32 v236, s39, 2
    s_nop 1
    buffer_load_dword v208, v236, s[72:75], s42 offen sc0 sc1
    s_waitcnt vmcnt(9) lgkmcnt(0)
    s_branch g1_10_afterwait
g1_10_ev14:
    s_cmp_eq_u32 s28, 0
    s_cbranch_scc0 g1_10_ev14b
    s_lshl_b32 s39, s29, 11
    s_sub_u32 s39, s39, 128
    v_add_u32 v236, s39, v216
    v_max_i32 v236, 0, v236
    s_add_u32 s39, s39, 1024
    v_add_u32 v237, s39, v216
    s_mov_b32 m0, 151552
    s_nop 0
    buffer_load_dwordx4 v236, s[64:67], 0 offen sc0 sc1 lds
    s_mov_b32 m0, 152576
    s_nop 0
    buffer_load_dwordx4 v237, s[64:67], 0 offen sc0 sc1 lds
    buffer_load_dwordx4 v237, s[64:67], 0 offen offset:1024 sc0 sc1 lds
    s_branch g1_10_ev14c
g1_10_ev14b:
    s_mul_i32 s39, s28, 3072
    s_sub_u32 s39, s39, 3072
    s_add_u32 m0, s39, 154624
    s_lshl_b32 s42, s76, 13
    s_add_u32 s42, s42, s39
    s_add_u32 s42, s42, 65536
    buffer_load_dwordx4 v216, s[64:67], s42 offen sc0 sc1 lds
    buffer_load_dwordx4 v216, s[64:67], s42 offen offset:1024 sc0 sc1 lds
    s_cmp_eq_u32 s28, 3
    s_cselect_b32 s39, 163840, m0
    s_mov_b32 m0, s39
    s_nop 0
    buffer_load_dwordx4 v216, s[64:67], s42 offen offset:2048 sc0 sc1 lds
g1_10_ev14c:
    s_mov_b32 s64, s92
    s_mov_b32 s65, s93
    s_mov_b32 s66, 2097152
    s_mov_b32 s72, s94
    s_mov_b32 s73, s95
    s_mov_b32 s74, 7340032
    s_mov_b32 s67, 0x20000
    s_mov_b32 s75, 0x20000
    s_lshl_b32 s39, s70, 2
    buffer_load_dwordx4 v[212:215], v216, s[64:67], s70 offen
    buffer_load_dwordx4 v[212:215], v216, s[72:75], s39 offen offset:0
    buffer_load_dwordx4 v[212:215], v216, s[72:75], s39 offen offset:1024
    buffer_load_dwordx4 v[212:215], v216, s[72:75], s39 offen offset:2048
    buffer_load_dwordx4 v[212:215], v216, s[72:75], s39 offen offset:3072
    s_waitcnt vmcnt(16) lgkmcnt(0)
    s_branch g1_10_afterwait
g1_10_post:
    v_mov_b32 v236, 0
    v_writelane_b32 v236, 32, 0
    v_writelane_b32 v236, 8, 1
    v_writelane_b32 v236, 32, 2
    s_nop 1
    v_cmp_ne_u32 vcc, v236, v208
    s_nop 3
    s_and_b32 s39, vcc_lo, 7
    v_mov_b32 v236, 163712
    v_mov_b32 v237, s39
    s_cmp_eq_u32 s24, 0
    s_cbranch_scc0 g1_10_red
    ds_write_b32 v236, v237
g1_10_red:
    s_lshl_b32 s39, s28, 8
    v_lshl_add_u32 v236, v250, 2, s39
    v_add_u32 v237, 154624, v236
    ds_read_b32 v112, v237 offset:0
    ds_read_b32 v113, v237 offset:1024
    ds_read_b32 v114, v237 offset:2048
    ds_read_b32 v115, v237 offset:3072
    ds_read_b32 v116, v237 offset:4096
    ds_read_b32 v117, v237 offset:5120
    ds_read_b32 v118, v237 offset:6144
    ds_read_b32 v119, v237 offset:7168
    v_min_u32 v236, 892, v236
    v_add_u32 v236, 162816, v236
    v_cmp_gt_u32 vcc, 155520, v237
    s_waitcnt lgkmcnt(0)
    v_add_f32 v112, v112, v113
    v_add_f32 v112, v112, v114
    v_add_f32 v112, v112, v115
    v_add_f32 v112, v112, v116
    v_add_f32 v112, v112, v117
    v_add_f32 v112, v112, v118
    v_add_f32 v112, v112, v119
    s_and_saveexec_b64 s[42:43], vcc
    ds_write_b32 v236, v112
    s_mov_b64 exec, -1
    s_waitcnt lgkmcnt(0)
    s_barrier
    v_mov_b32 v236, 163712
    ds_read_b32 v237, v236
    s_waitcnt lgkmcnt(0)
    v_readfirstlane_b32 s39, v237
    s_nop 3
    s_cmp_eq_u32 s39, 0
    s_cbranch_scc1 g1_10_fast
    s_barrier
    s_mov_b32 s14, 4194304
    s_mov_b32 s18, 7340032
    s_mov_b32 s31, s24
g1_10_slow1:
    s_lshl_b32 s39, s29, 8
    s_add_u32 s39, s39, s31
    s_sub_u32 s39, s39, 16
    s_max_i32 s39, s39, 0
    s_lshl_b32 s39, s39, 11
    buffer_load_dwordx4 v[112:115], v216, s[12:15], s39 offen
    buffer_load_dwordx4 v[116:119], v216, s[12:15], s39 offen offset:1024
    s_waitcnt vmcnt(0)
    v_lshlrev_b32 v144, 16, v112
    v_and_b32 v145, 0xffff0000, v112
    v_lshlrev_b32 v146, 16, v113
    v_and_b32 v147, 0xffff0000, v113
    v_lshlrev_b32 v148, 16, v114
    v_and_b32 v149, 0xffff0000, v114
    v_lshlrev_b32 v150, 16, v115
    v_and_b32 v151, 0xffff0000, v115
    v_lshlrev_b32 v152, 16, v116
    v_and_b32 v153, 0xffff0000, v116
    v_lshlrev_b32 v154, 16, v117
    v_and_b32 v155, 0xffff0000, v117
    v_lshlrev_b32 v156, 16, v118
    v_and_b32 v157, 0xffff0000, v118
    v_lshlrev_b32 v158, 16, v119
    v_and_b32 v159, 0xffff0000, v119
    v_pk_add_f32 v[160:161], v[144:145], v[146:147]
    v_pk_add_f32 v[160:161], v[160:161], v[148:149]
    v_pk_add_f32 v[160:161], v[160:161], v[150:151]
    v_pk_add_f32 v[160:161], v[160:161], v[152:153]
    v_pk_add_f32 v[160:161], v[160:161], v[154:155]
    v_pk_add_f32 v[160:161], v[160:161], v[156:157]
    v_pk_add_f32 v[160:161], v[160:161], v[158:159]
    v_add_f32 v164, v160, v161
    s_nop 1
    v_add_f32_dpp v165, v164, v164 quad_perm:[1,0,3,2] row_mask:0xf bank_mask:0xf
    s_nop 1
    v_add_f32_dpp v164, v165, v165 quad_perm:[2,3,0,1] row_mask:0xf bank_mask:0xf
    s_nop 1
    v_add_f32_dpp v165, v164, v164 row_half_mirror row_mask:0xf bank_mask:0xf
    s_nop 1
    v_add_f32_dpp v164, v165, v165 row_mirror row_mask:0xf bank_mask:0xf
    v_mov_b32 v165, v164
    s_nop 1
    v_permlane16_swap_b32 v164, v165
    s_nop 1
    v_add_f32 v164, v164, v165
    v_mov_b32 v165, v164
    s_nop 1
    v_permlane32_swap_b32 v164, v165
    s_nop 1
    v_add_f32 v164, v164, v165
    v_mul_f32 v164, 0x3a800000, v164
    v_pk_add_f32 v[144:145], v[144:145], v[164:165] op_sel_hi:[1,0] neg_lo:[0,1] neg_hi:[0,1]
    v_pk_add_f32 v[146:147], v[146:147], v[164:165] op_sel_hi:[1,0] neg_lo:[0,1] neg_hi:[0,1]
    v_pk_add_f32 v[148:149], v[148:149], v[164:165] op_sel_hi:[1,0] neg_lo:[0,1] neg_hi:[0,1]
    v_pk_add_f32 v[150:151], v[150:151], v[164:165] op_sel_hi:[1,0] neg_lo:[0,1] neg_hi:[0,1]
    v_pk_add_f32 v[152:153], v[152:153], v[164:165] op_sel_hi:[1,0] neg_lo:[0,1] neg_hi:[0,1]
    v_pk_add_f32 v[154:155], v[154:155], v[164:165] op_sel_hi:[1,0] neg_lo:[0,1] neg_hi:[0,1]
    v_pk_add_f32 v[156:157], v[156:157], v[164:165] op_sel_hi:[1,0] neg_lo:[0,1] neg_hi:[0,1]
    v_pk_add_f32 v[158:159], v[158:159], v[164:165] op_sel_hi:[1,0] neg_lo:[0,1] neg_hi:[0,1]
    v_pk_mul_f32 v[160:161], v[144:145], v[144:145]
    v_pk_fma_f32 v[160:161], v[146:147], v[146:147], v[160:161]
    v_pk_fma_f32 v[160:161], v[148:149], v[148:149], v[160:161]
    v_pk_fma_f32 v[160:161], v[150:151], v[150:151], v[160:161]
    v_pk_fma_f32 v[160:161], v[152:153], v[152:153], v[160:161]
    v_pk_fma_f32 v[160:161], v[154:155], v[154:155], v[160:161]
    v_pk_fma_f32 v[160:161], v[156:157], v[156:157], v[160:161]
    v_pk_fma_f32 v[160:161], v[158:159], v[158:159], v[160:161]
    v_add_f32 v161, v160, v161
    s_nop 1
    v_add_f32_dpp v165, v161, v161 quad_perm:[1,0,3,2] row_mask:0xf bank_mask:0xf
    s_nop 1
    v_add_f32_dpp v161, v165, v165 quad_perm:[2,3,0,1] row_mask:0xf bank_mask:0xf
    s_nop 1
    v_add_f32_dpp v165, v161, v161 row_half_mirror row_mask:0xf bank_mask:0xf
    s_nop 1
    v_add_f32_dpp v161, v165, v165 row_mirror row_mask:0xf bank_mask:0xf
    v_mov_b32 v165, v161
    s_nop 1
    v_permlane16_swap_b32 v161, v165
    s_nop 1
    v_add_f32 v161, v161, v165
    v_mov_b32 v165, v161
    s_nop 1
    v_permlane32_swap_b32 v161, v165
    s_nop 1
    v_add_f32 v161, v161, v165
    v_mul_f32 v161, 0x3a800000, v161
    v_cvt_pk_bf16_f32 v165, v164, v161
    v_lshlrev_b32 v160, 16, v165
    v_and_b32 v161, 0xffff0000, v165
    v_add_f32 v161, 0x3727c5ac, v161
    v_cvt_pk_bf16_f32 v161, v161, v161
    v_and_b32 v161, 0xffff0000, v161
    v_sqrt_f32 v161, v161
    s_nop 0
    v_cvt_pk_bf16_f32 v161, v161, v161
    v_and_b32 v161, 0xffff0000, v161
    v_rcp_f32 v161, v161
    s_nop 0
    s_lshl_b32 s39, s31, 3
    s_add_u32 s39, s39, 151552
    v_mov_b32 v236, s39
    ds_write_b64 v236, v[160:161]
    s_add_u32 s31, s31, 8
    s_cmp_lt_u32 s31, 272
    s_cbranch_scc1 g1_10_slow1
    v_min_u32 v236, 27, v250
    s_mul_i32 s39, s30, 448
    v_lshl_add_u32 v239, v236, 4, s39
    v_mov_b32 v144, 0
    v_mov_b32 v145, 0
    v_mov_b32 v146, 0
    v_mov_b32 v147, 0
    v_mov_b32 v148, 0
    v_mov_b32 v149, 0
    v_mov_b32 v150, 0
    v_mov_b32 v151, 0
    s_mul_i32 s39, s24, 917504
    s_mov_b32 s31, 0
g1_10_slow2:
    buffer_load_dwordx4 v[112:115], v239, s[16:19], s39 offen
    s_add_u32 s39, s39, 7168
    s_add_u32 s31, s31, 1
    s_waitcnt vmcnt(0)
    v_lshlrev_b32 v116, 16, v112
    v_and_b32 v117, 0xffff0000, v112
    v_pk_add_f32 v[144:145], v[144:145], v[116:117]
    v_lshlrev_b32 v116, 16, v113
    v_and_b32 v117, 0xffff0000, v113
    v_pk_add_f32 v[146:147], v[146:147], v[116:117]
    v_lshlrev_b32 v116, 16, v114
    v_and_b32 v117, 0xffff0000, v114
    v_pk_add_f32 v[148:149], v[148:149], v[116:117]
    v_lshlrev_b32 v116, 16, v115
    v_and_b32 v117, 0xffff0000, v115
    v_pk_add_f32 v[150:151], v[150:151], v[116:117]
    s_cmp_lt_u32 s31, 128
    s_cbranch_scc1 g1_10_slow2
    s_lshl_b32 s39, s24, 10
    s_add_u32 s39, s39, 154624
    v_lshl_add_u32 v236, v236, 5, s39
    ds_write_b128 v236, v[144:147]
    ds_write_b128 v236, v[148:151] offset:16
    v_mov_b32 v236, 163712
    v_mov_b32 v237, 0
    ds_write_b32 v236, v237
    s_waitcnt lgkmcnt(0)
    s_barrier
    s_branch g1_10_red
g1_10_fast:
    s_lshl_b32 s39, s26, 6
    s_lshl_b32 s42, s27, 5
    s_xor_b32 s42, s42, 0
    s_add_u32 s39, s39, s42
    s_add_u32 s52, s39, 0
    s_lshl_b32 s39, s26, 6
    s_lshl_b32 s42, s27, 5
    s_xor_b32 s42, s42, 16
    s_add_u32 s39, s39, s42
    s_add_u32 s53, s39, 0
    s_lshl_b32 s39, s26, 6
    s_lshl_b32 s42, s27, 5
    s_xor_b32 s42, s42, 32
    s_add_u32 s39, s39, s42
    s_add_u32 s54, s39, 0
    s_lshl_b32 s39, s26, 6
    s_lshl_b32 s42, s27, 5
    s_xor_b32 s42, s42, 48
    s_add_u32 s39, s39, s42
    s_add_u32 s55, s39, 0
    s_add_u32 s39, s52, 18960
    v_add_u32 v240, s39, v251
    v_lshlrev_b32 v240, 3, v240
    ds_read_b64 v[112:113], v240
    s_add_u32 s39, s53, 18960
    v_add_u32 v240, s39, v251
    v_lshlrev_b32 v240, 3, v240
    ds_read_b64 v[114:115], v240
    s_add_u32 s39, s54, 18960
    v_add_u32 v240, s39, v251
    v_lshlrev_b32 v240, 3, v240
    ds_read_b64 v[116:117], v240
    s_add_u32 s39, s55, 18960
    v_add_u32 v240, s39, v251
    v_lshlrev_b32 v240, 3, v240
    ds_read_b64 v[118:119], v240
    s_lshl_b32 s39, s44, 6
    s_add_u32 s39, s39, 162816
    v_lshl_add_u32 v240, v252, 4, s39
    ds_read_b128 v[144:147], v240
    s_lshl_b32 s39, s45, 6
    s_add_u32 s39, s39, 162816
    v_lshl_add_u32 v240, v252, 4, s39
    ds_read_b128 v[148:151], v240
    s_lshl_b32 s39, s46, 6
    s_add_u32 s39, s39, 162816
    v_lshl_add_u32 v240, v252, 4, s39
    ds_read_b128 v[152:155], v240
    s_lshl_b32 s39, s47, 6
    s_add_u32 s39, s39, 162816
    v_lshl_add_u32 v240, v252, 4, s39
    ds_read_b128 v[156:159], v240
    s_lshl_b32 s39, s48, 6
    s_add_u32 s39, s39, 162816
    v_lshl_add_u32 v240, v252, 4, s39
    ds_read_b128 v[160:163], v240
    s_lshl_b32 s39, s49, 6
    s_add_u32 s39, s39, 162816
    v_lshl_add_u32 v240, v252, 4, s39
    ds_read_b128 v[164:167], v240
    s_lshl_b32 s39, s50, 6
    s_add_u32 s39, s39, 162816
    v_lshl_add_u32 v240, v252, 4, s39
    ds_read_b128 v[168:171], v240
    s_waitcnt lgkmcnt(0)
    v_and_b32 v236, 1, v252
    v_lshrrev_b32 v237, 1, v252
    v_lshl_or_b32 v244, v236, 1, v237
    v_lshl_add_u32 v245, v244, 4, v251
    v_lshlrev_b32 v245, 4, v245
    s_lshl_b32 s39, s27, 1
    v_add_u32 v237, s39, v237
    v_lshl_add_u32 v246, v237, 4, v251
    v_lshlrev_b32 v246, 4, v246
    v_lshl_add_u32 v246, v236, 3, v246
    s_lshr_b32 s39, s52, 4
    s_lshl_b32 s42, s29, 4
    s_add_u32 s39, s39, s42
    s_mul_i32 s52, s39, 147456
    s_lshr_b32 s39, s53, 4
    s_lshl_b32 s42, s29, 4
    s_add_u32 s39, s39, s42
    s_mul_i32 s53, s39, 147456
    s_lshr_b32 s39, s54, 4
    s_lshl_b32 s42, s29, 4
    s_add_u32 s39, s39, s42
    s_mul_i32 s54, s39, 147456
    s_lshr_b32 s39, s55, 4
    s_lshl_b32 s42, s29, 4
    s_add_u32 s39, s39, s42
    s_mul_i32 s55, s39, 147456
    s_mul_i32 s42, s30, 7
    s_add_u32 s42, s42, 32
    s_lshr_b32 s39, s44, 1
    s_add_u32 s39, s39, s42
    s_lshl_b32 s56, s39, 10
    s_lshr_b32 s39, s46, 1
    s_add_u32 s39, s39, s42
    s_lshl_b32 s57, s39, 10
    s_lshr_b32 s39, s48, 1
    s_add_u32 s39, s39, s42
    s_lshl_b32 s58, s39, 10
    s_lshr_b32 s39, s50, 1
    s_add_u32 s39, s39, s42
    s_lshl_b32 s59, s39, 10
    v_pk_fma_f32 v[0:1], v[144:145], v[112:113], v[0:1] op_sel_hi:[1,0,1] neg_lo:[0,1,0] neg_hi:[0,1,0]
    v_pk_fma_f32 v[2:3], v[146:147], v[112:113], v[2:3] op_sel_hi:[1,0,1] neg_lo:[0,1,0] neg_hi:[0,1,0]
    v_pk_mul_f32 v[0:1], v[0:1], v[112:113] op_sel:[0,1] op_sel_hi:[1,1]
    v_pk_mul_f32 v[2:3], v[2:3], v[112:113] op_sel:[0,1] op_sel_hi:[1,1]
    v_cvt_pk_bf16_f32 v128, v0, v1
    v_cvt_pk_bf16_f32 v129, v2, v3
    v_pk_max_i16 v128, v128, 0
    v_pk_max_i16 v129, v129, 0
    v_pk_fma_f32 v[16:17], v[148:149], v[112:113], v[16:17] op_sel_hi:[1,0,1] neg_lo:[0,1,0] neg_hi:[0,1,0]
    v_pk_fma_f32 v[18:19], v[150:151], v[112:113], v[18:19] op_sel_hi:[1,0,1] neg_lo:[0,1,0] neg_hi:[0,1,0]
    v_pk_mul_f32 v[16:17], v[16:17], v[112:113] op_sel:[0,1] op_sel_hi:[1,1]
    v_pk_mul_f32 v[18:19], v[18:19], v[112:113] op_sel:[0,1] op_sel_hi:[1,1]
    v_cvt_pk_bf16_f32 v130, v16, v17
    v_cvt_pk_bf16_f32 v131, v18, v19
    v_pk_max_i16 v130, v130, 0
    v_pk_max_i16 v131, v131, 0
    s_add_u32 s39, s52, s56
    s_nop 0
    v_permlane16_swap_b32 v128, v130
    v_permlane16_swap_b32 v129, v131
    s_nop 1
    buffer_store_dwordx4 v[128:131], v245, s[20:23], s39 offen
    v_pk_fma_f32 v[32:33], v[152:153], v[112:113], v[32:33] op_sel_hi:[1,0,1] neg_lo:[0,1,0] neg_hi:[0,1,0]
    v_pk_fma_f32 v[34:35], v[154:155], v[112:113], v[34:35] op_sel_hi:[1,0,1] neg_lo:[0,1,0] neg_hi:[0,1,0]
    v_pk_mul_f32 v[32:33], v[32:33], v[112:113] op_sel:[0,1] op_sel_hi:[1,1]
    v_pk_mul_f32 v[34:35], v[34:35], v[112:113] op_sel:[0,1] op_sel_hi:[1,1]
    v_cvt_pk_bf16_f32 v132, v32, v33
    v_cvt_pk_bf16_f32 v133, v34, v35
    v_pk_max_i16 v132, v132, 0
    v_pk_max_i16 v133, v133, 0
    v_pk_fma_f32 v[48:49], v[156:157], v[112:113], v[48:49] op_sel_hi:[1,0,1] neg_lo:[0,1,0] neg_hi:[0,1,0]
    v_pk_fma_f32 v[50:51], v[158:159], v[112:113], v[50:51] op_sel_hi:[1,0,1] neg_lo:[0,1,0] neg_hi:[0,1,0]
    v_pk_mul_f32 v[48:49], v[48:49], v[112:113] op_sel:[0,1] op_sel_hi:[1,1]
    v_pk_mul_f32 v[50:51], v[50:51], v[112:113] op_sel:[0,1] op_sel_hi:[1,1]
    v_cvt_pk_bf16_f32 v134, v48, v49
    v_cvt_pk_bf16_f32 v135, v50, v51
    v_pk_max_i16 v134, v134, 0
    v_pk_max_i16 v135, v135, 0
    s_add_u32 s39, s52, s57
    s_nop 0
    v_permlane16_swap_b32 v132, v134
    v_permlane16_swap_b32 v133, v135
    s_nop 1
    buffer_store_dwordx4 v[132:135], v245, s[20:23], s39 offen
    v_pk_fma_f32 v[64:65], v[160:161], v[112:113], v[64:65] op_sel_hi:[1,0,1] neg_lo:[0,1,0] neg_hi:[0,1,0]
    v_pk_fma_f32 v[66:67], v[162:163], v[112:113], v[66:67] op_sel_hi:[1,0,1] neg_lo:[0,1,0] neg_hi:[0,1,0]
    v_pk_mul_f32 v[64:65], v[64:65], v[112:113] op_sel:[0,1] op_sel_hi:[1,1]
    v_pk_mul_f32 v[66:67], v[66:67], v[112:113] op_sel:[0,1] op_sel_hi:[1,1]
    v_cvt_pk_bf16_f32 v136, v64, v65
    v_cvt_pk_bf16_f32 v137, v66, v67
    v_pk_max_i16 v136, v136, 0
    v_pk_max_i16 v137, v137, 0
    v_pk_fma_f32 v[80:81], v[164:165], v[112:113], v[80:81] op_sel_hi:[1,0,1] neg_lo:[0,1,0] neg_hi:[0,1,0]
    v_pk_fma_f32 v[82:83], v[166:167], v[112:113], v[82:83] op_sel_hi:[1,0,1] neg_lo:[0,1,0] neg_hi:[0,1,0]
    v_pk_mul_f32 v[80:81], v[80:81], v[112:113] op_sel:[0,1] op_sel_hi:[1,1]
    v_pk_mul_f32 v[82:83], v[82:83], v[112:113] op_sel:[0,1] op_sel_hi:[1,1]
    v_cvt_pk_bf16_f32 v138, v80, v81
    v_cvt_pk_bf16_f32 v139, v82, v83
    v_pk_max_i16 v138, v138, 0
    v_pk_max_i16 v139, v139, 0
    s_add_u32 s39, s52, s58
    s_nop 0
    v_permlane16_swap_b32 v136, v138
    v_permlane16_swap_b32 v137, v139
    s_nop 1
    buffer_store_dwordx4 v[136:139], v245, s[20:23], s39 offen
    v_pk_fma_f32 v[96:97], v[168:169], v[112:113], v[96:97] op_sel_hi:[1,0,1] neg_lo:[0,1,0] neg_hi:[0,1,0]
    v_pk_fma_f32 v[98:99], v[170:171], v[112:113], v[98:99] op_sel_hi:[1,0,1] neg_lo:[0,1,0] neg_hi:[0,1,0]
    v_pk_mul_f32 v[96:97], v[96:97], v[112:113] op_sel:[0,1] op_sel_hi:[1,1]
    v_pk_mul_f32 v[98:99], v[98:99], v[112:113] op_sel:[0,1] op_sel_hi:[1,1]
    v_cvt_pk_bf16_f32 v140, v96, v97
    v_cvt_pk_bf16_f32 v141, v98, v99
    v_pk_max_i16 v140, v140, 0
    v_pk_max_i16 v141, v141, 0
    s_add_u32 s39, s52, s59
    s_nop 1
    buffer_store_dwordx2 v[140:141], v246, s[20:23], s39 offen
    v_pk_fma_f32 v[4:5], v[144:145], v[114:115], v[4:5] op_sel_hi:[1,0,1] neg_lo:[0,1,0] neg_hi:[0,1,0]
    v_pk_fma_f32 v[6:7], v[146:147], v[114:115], v[6:7] op_sel_hi:[1,0,1] neg_lo:[0,1,0] neg_hi:[0,1,0]
    v_pk_mul_f32 v[4:5], v[4:5], v[114:115] op_sel:[0,1] op_sel_hi:[1,1]
    v_pk_mul_f32 v[6:7], v[6:7], v[114:115] op_sel:[0,1] op_sel_hi:[1,1]
    v_cvt_pk_bf16_f32 v128, v4, v5
    v_cvt_pk_bf16_f32 v129, v6, v7
    v_pk_max_i16 v128, v128, 0
    v_pk_max_i16 v129, v129, 0
    v_pk_fma_f32 v[20:21], v[148:149], v[114:115], v[20:21] op_sel_hi:[1,0,1] neg_lo:[0,1,0] neg_hi:[0,1,0]
    v_pk_fma_f32 v[22:23], v[150:151], v[114:115], v[22:23] op_sel_hi:[1,0,1] neg_lo:[0,1,0] neg_hi:[0,1,0]
    v_pk_mul_f32 v[20:21], v[20:21], v[114:115] op_sel:[0,1] op_sel_hi:[1,1]
    v_pk_mul_f32 v[22:23], v[22:23], v[114:115] op_sel:[0,1] op_sel_hi:[1,1]
    v_cvt_pk_bf16_f32 v130, v20, v21
    v_cvt_pk_bf16_f32 v131, v22, v23
    v_pk_max_i16 v130, v130, 0
    v_pk_max_i16 v131, v131, 0
    s_add_u32 s39, s53, s56
    s_nop 0
    v_permlane16_swap_b32 v128, v130
    v_permlane16_swap_b32 v129, v131
    s_nop 1
    buffer_store_dwordx4 v[128:131], v245, s[20:23], s39 offen
    v_pk_fma_f32 v[36:37], v[152:153], v[114:115], v[36:37] op_sel_hi:[1,0,1] neg_lo:[0,1,0] neg_hi:[0,1,0]
    v_pk_fma_f32 v[38:39], v[154:155], v[114:115], v[38:39] op_sel_hi:[1,0,1] neg_lo:[0,1,0] neg_hi:[0,1,0]
    v_pk_mul_f32 v[36:37], v[36:37], v[114:115] op_sel:[0,1] op_sel_hi:[1,1]
    v_pk_mul_f32 v[38:39], v[38:39], v[114:115] op_sel:[0,1] op_sel_hi:[1,1]
    v_cvt_pk_bf16_f32 v132, v36, v37
    v_cvt_pk_bf16_f32 v133, v38, v39
    v_pk_max_i16 v132, v132, 0
    v_pk_max_i16 v133, v133, 0
    v_pk_fma_f32 v[52:53], v[156:157], v[114:115], v[52:53] op_sel_hi:[1,0,1] neg_lo:[0,1,0] neg_hi:[0,1,0]
    v_pk_fma_f32 v[54:55], v[158:159], v[114:115], v[54:55] op_sel_hi:[1,0,1] neg_lo:[0,1,0] neg_hi:[0,1,0]
    v_pk_mul_f32 v[52:53], v[52:53], v[114:115] op_sel:[0,1] op_sel_hi:[1,1]
    v_pk_mul_f32 v[54:55], v[54:55], v[114:115] op_sel:[0,1] op_sel_hi:[1,1]
    v_cvt_pk_bf16_f32 v134, v52, v53
    v_cvt_pk_bf16_f32 v135, v54, v55
    v_pk_max_i16 v134, v134, 0
    v_pk_max_i16 v135, v135, 0
    s_add_u32 s39, s53, s57
    s_nop 0
    v_permlane16_swap_b32 v132, v134
    v_permlane16_swap_b32 v133, v135
    s_nop 1
    buffer_store_dwordx4 v[132:135], v245, s[20:23], s39 offen
    v_pk_fma_f32 v[68:69], v[160:161], v[114:115], v[68:69] op_sel_hi:[1,0,1] neg_lo:[0,1,0] neg_hi:[0,1,0]
    v_pk_fma_f32 v[70:71], v[162:163], v[114:115], v[70:71] op_sel_hi:[1,0,1] neg_lo:[0,1,0] neg_hi:[0,1,0]
    v_pk_mul_f32 v[68:69], v[68:69], v[114:115] op_sel:[0,1] op_sel_hi:[1,1]
    v_pk_mul_f32 v[70:71], v[70:71], v[114:115] op_sel:[0,1] op_sel_hi:[1,1]
    v_cvt_pk_bf16_f32 v136, v68, v69
    v_cvt_pk_bf16_f32 v137, v70, v71
    v_pk_max_i16 v136, v136, 0
    v_pk_max_i16 v137, v137, 0
    v_pk_fma_f32 v[84:85], v[164:165], v[114:115], v[84:85] op_sel_hi:[1,0,1] neg_lo:[0,1,0] neg_hi:[0,1,0]
    v_pk_fma_f32 v[86:87], v[166:167], v[114:115], v[86:87] op_sel_hi:[1,0,1] neg_lo:[0,1,0] neg_hi:[0,1,0]
    v_pk_mul_f32 v[84:85], v[84:85], v[114:115] op_sel:[0,1] op_sel_hi:[1,1]
    v_pk_mul_f32 v[86:87], v[86:87], v[114:115] op_sel:[0,1] op_sel_hi:[1,1]
    v_cvt_pk_bf16_f32 v138, v84, v85
    v_cvt_pk_bf16_f32 v139, v86, v87
    v_pk_max_i16 v138, v138, 0
    v_pk_max_i16 v139, v139, 0
    s_add_u32 s39, s53, s58
    s_nop 0
    v_permlane16_swap_b32 v136, v138
    v_permlane16_swap_b32 v137, v139
    s_nop 1
    buffer_store_dwordx4 v[136:139], v245, s[20:23], s39 offen
    v_pk_fma_f32 v[100:101], v[168:169], v[114:115], v[100:101] op_sel_hi:[1,0,1] neg_lo:[0,1,0] neg_hi:[0,1,0]
    v_pk_fma_f32 v[102:103], v[170:171], v[114:115], v[102:103] op_sel_hi:[1,0,1] neg_lo:[0,1,0] neg_hi:[0,1,0]
    v_pk_mul_f32 v[100:101], v[100:101], v[114:115] op_sel:[0,1] op_sel_hi:[1,1]
    v_pk_mul_f32 v[102:103], v[102:103], v[114:115] op_sel:[0,1] op_sel_hi:[1,1]
    v_cvt_pk_bf16_f32 v140, v100, v101
    v_cvt_pk_bf16_f32 v141, v102, v103
    v_pk_max_i16 v140, v140, 0
    v_pk_max_i16 v141, v141, 0
    s_add_u32 s39, s53, s59
    s_nop 1
    buffer_store_dwordx2 v[140:141], v246, s[20:23], s39 offen
    v_pk_fma_f32 v[8:9], v[144:145], v[116:117], v[8:9] op_sel_hi:[1,0,1] neg_lo:[0,1,0] neg_hi:[0,1,0]
    v_pk_fma_f32 v[10:11], v[146:147], v[116:117], v[10:11] op_sel_hi:[1,0,1] neg_lo:[0,1,0] neg_hi:[0,1,0]
    v_pk_mul_f32 v[8:9], v[8:9], v[116:117] op_sel:[0,1] op_sel_hi:[1,1]
    v_pk_mul_f32 v[10:11], v[10:11], v[116:117] op_sel:[0,1] op_sel_hi:[1,1]
    v_cvt_pk_bf16_f32 v128, v8, v9
    v_cvt_pk_bf16_f32 v129, v10, v11
    v_pk_max_i16 v128, v128, 0
    v_pk_max_i16 v129, v129, 0
    v_pk_fma_f32 v[24:25], v[148:149], v[116:117], v[24:25] op_sel_hi:[1,0,1] neg_lo:[0,1,0] neg_hi:[0,1,0]
    v_pk_fma_f32 v[26:27], v[150:151], v[116:117], v[26:27] op_sel_hi:[1,0,1] neg_lo:[0,1,0] neg_hi:[0,1,0]
    v_pk_mul_f32 v[24:25], v[24:25], v[116:117] op_sel:[0,1] op_sel_hi:[1,1]
    v_pk_mul_f32 v[26:27], v[26:27], v[116:117] op_sel:[0,1] op_sel_hi:[1,1]
    v_cvt_pk_bf16_f32 v130, v24, v25
    v_cvt_pk_bf16_f32 v131, v26, v27
    v_pk_max_i16 v130, v130, 0
    v_pk_max_i16 v131, v131, 0
    s_add_u32 s39, s54, s56
    s_nop 0
    v_permlane16_swap_b32 v128, v130
    v_permlane16_swap_b32 v129, v131
    s_nop 1
    buffer_store_dwordx4 v[128:131], v245, s[20:23], s39 offen
    v_pk_fma_f32 v[40:41], v[152:153], v[116:117], v[40:41] op_sel_hi:[1,0,1] neg_lo:[0,1,0] neg_hi:[0,1,0]
    v_pk_fma_f32 v[42:43], v[154:155], v[116:117], v[42:43] op_sel_hi:[1,0,1] neg_lo:[0,1,0] neg_hi:[0,1,0]
    v_pk_mul_f32 v[40:41], v[40:41], v[116:117] op_sel:[0,1] op_sel_hi:[1,1]
    v_pk_mul_f32 v[42:43], v[42:43], v[116:117] op_sel:[0,1] op_sel_hi:[1,1]
    v_cvt_pk_bf16_f32 v132, v40, v41
    v_cvt_pk_bf16_f32 v133, v42, v43
    v_pk_max_i16 v132, v132, 0
    v_pk_max_i16 v133, v133, 0
    v_pk_fma_f32 v[56:57], v[156:157], v[116:117], v[56:57] op_sel_hi:[1,0,1] neg_lo:[0,1,0] neg_hi:[0,1,0]
    v_pk_fma_f32 v[58:59], v[158:159], v[116:117], v[58:59] op_sel_hi:[1,0,1] neg_lo:[0,1,0] neg_hi:[0,1,0]
    v_pk_mul_f32 v[56:57], v[56:57], v[116:117] op_sel:[0,1] op_sel_hi:[1,1]
    v_pk_mul_f32 v[58:59], v[58:59], v[116:117] op_sel:[0,1] op_sel_hi:[1,1]
    v_cvt_pk_bf16_f32 v134, v56, v57
    v_cvt_pk_bf16_f32 v135, v58, v59
    v_pk_max_i16 v134, v134, 0
    v_pk_max_i16 v135, v135, 0
    s_add_u32 s39, s54, s57
    s_nop 0
    v_permlane16_swap_b32 v132, v134
    v_permlane16_swap_b32 v133, v135
    s_nop 1
    buffer_store_dwordx4 v[132:135], v245, s[20:23], s39 offen
    v_pk_fma_f32 v[72:73], v[160:161], v[116:117], v[72:73] op_sel_hi:[1,0,1] neg_lo:[0,1,0] neg_hi:[0,1,0]
    v_pk_fma_f32 v[74:75], v[162:163], v[116:117], v[74:75] op_sel_hi:[1,0,1] neg_lo:[0,1,0] neg_hi:[0,1,0]
    v_pk_mul_f32 v[72:73], v[72:73], v[116:117] op_sel:[0,1] op_sel_hi:[1,1]
    v_pk_mul_f32 v[74:75], v[74:75], v[116:117] op_sel:[0,1] op_sel_hi:[1,1]
    v_cvt_pk_bf16_f32 v136, v72, v73
    v_cvt_pk_bf16_f32 v137, v74, v75
    v_pk_max_i16 v136, v136, 0
    v_pk_max_i16 v137, v137, 0
    v_pk_fma_f32 v[88:89], v[164:165], v[116:117], v[88:89] op_sel_hi:[1,0,1] neg_lo:[0,1,0] neg_hi:[0,1,0]
    v_pk_fma_f32 v[90:91], v[166:167], v[116:117], v[90:91] op_sel_hi:[1,0,1] neg_lo:[0,1,0] neg_hi:[0,1,0]
    v_pk_mul_f32 v[88:89], v[88:89], v[116:117] op_sel:[0,1] op_sel_hi:[1,1]
    v_pk_mul_f32 v[90:91], v[90:91], v[116:117] op_sel:[0,1] op_sel_hi:[1,1]
    v_cvt_pk_bf16_f32 v138, v88, v89
    v_cvt_pk_bf16_f32 v139, v90, v91
    v_pk_max_i16 v138, v138, 0
    v_pk_max_i16 v139, v139, 0
    s_add_u32 s39, s54, s58
    s_nop 0
    v_permlane16_swap_b32 v136, v138
    v_permlane16_swap_b32 v137, v139
    s_nop 1
    buffer_store_dwordx4 v[136:139], v245, s[20:23], s39 offen
    v_pk_fma_f32 v[104:105], v[168:169], v[116:117], v[104:105] op_sel_hi:[1,0,1] neg_lo:[0,1,0] neg_hi:[0,1,0]
    v_pk_fma_f32 v[106:107], v[170:171], v[116:117], v[106:107] op_sel_hi:[1,0,1] neg_lo:[0,1,0] neg_hi:[0,1,0]
    v_pk_mul_f32 v[104:105], v[104:105], v[116:117] op_sel:[0,1] op_sel_hi:[1,1]
    v_pk_mul_f32 v[106:107], v[106:107], v[116:117] op_sel:[0,1] op_sel_hi:[1,1]
    v_cvt_pk_bf16_f32 v140, v104, v105
    v_cvt_pk_bf16_f32 v141, v106, v107
    v_pk_max_i16 v140, v140, 0
    v_pk_max_i16 v141, v141, 0
    s_add_u32 s39, s54, s59
    s_nop 1
    buffer_store_dwordx2 v[140:141], v246, s[20:23], s39 offen
    v_pk_fma_f32 v[12:13], v[144:145], v[118:119], v[12:13] op_sel_hi:[1,0,1] neg_lo:[0,1,0] neg_hi:[0,1,0]
    v_pk_fma_f32 v[14:15], v[146:147], v[118:119], v[14:15] op_sel_hi:[1,0,1] neg_lo:[0,1,0] neg_hi:[0,1,0]
    v_pk_mul_f32 v[12:13], v[12:13], v[118:119] op_sel:[0,1] op_sel_hi:[1,1]
    v_pk_mul_f32 v[14:15], v[14:15], v[118:119] op_sel:[0,1] op_sel_hi:[1,1]
    v_cvt_pk_bf16_f32 v128, v12, v13
    v_cvt_pk_bf16_f32 v129, v14, v15
    v_pk_max_i16 v128, v128, 0
    v_pk_max_i16 v129, v129, 0
    v_pk_fma_f32 v[28:29], v[148:149], v[118:119], v[28:29] op_sel_hi:[1,0,1] neg_lo:[0,1,0] neg_hi:[0,1,0]
    v_pk_fma_f32 v[30:31], v[150:151], v[118:119], v[30:31] op_sel_hi:[1,0,1] neg_lo:[0,1,0] neg_hi:[0,1,0]
    v_pk_mul_f32 v[28:29], v[28:29], v[118:119] op_sel:[0,1] op_sel_hi:[1,1]
    v_pk_mul_f32 v[30:31], v[30:31], v[118:119] op_sel:[0,1] op_sel_hi:[1,1]
    v_cvt_pk_bf16_f32 v130, v28, v29
    v_cvt_pk_bf16_f32 v131, v30, v31
    v_pk_max_i16 v130, v130, 0
    v_pk_max_i16 v131, v131, 0
    s_add_u32 s39, s55, s56
    s_nop 0
    v_permlane16_swap_b32 v128, v130
    v_permlane16_swap_b32 v129, v131
    s_nop 1
    buffer_store_dwordx4 v[128:131], v245, s[20:23], s39 offen
    v_pk_fma_f32 v[44:45], v[152:153], v[118:119], v[44:45] op_sel_hi:[1,0,1] neg_lo:[0,1,0] neg_hi:[0,1,0]
    v_pk_fma_f32 v[46:47], v[154:155], v[118:119], v[46:47] op_sel_hi:[1,0,1] neg_lo:[0,1,0] neg_hi:[0,1,0]
    v_pk_mul_f32 v[44:45], v[44:45], v[118:119] op_sel:[0,1] op_sel_hi:[1,1]
    v_pk_mul_f32 v[46:47], v[46:47], v[118:119] op_sel:[0,1] op_sel_hi:[1,1]
    v_cvt_pk_bf16_f32 v132, v44, v45
    v_cvt_pk_bf16_f32 v133, v46, v47
    v_pk_max_i16 v132, v132, 0
    v_pk_max_i16 v133, v133, 0
    v_pk_fma_f32 v[60:61], v[156:157], v[118:119], v[60:61] op_sel_hi:[1,0,1] neg_lo:[0,1,0] neg_hi:[0,1,0]
    v_pk_fma_f32 v[62:63], v[158:159], v[118:119], v[62:63] op_sel_hi:[1,0,1] neg_lo:[0,1,0] neg_hi:[0,1,0]
    v_pk_mul_f32 v[60:61], v[60:61], v[118:119] op_sel:[0,1] op_sel_hi:[1,1]
    v_pk_mul_f32 v[62:63], v[62:63], v[118:119] op_sel:[0,1] op_sel_hi:[1,1]
    v_cvt_pk_bf16_f32 v134, v60, v61
    v_cvt_pk_bf16_f32 v135, v62, v63
    v_pk_max_i16 v134, v134, 0
    v_pk_max_i16 v135, v135, 0
    s_add_u32 s39, s55, s57
    s_nop 0
    v_permlane16_swap_b32 v132, v134
    v_permlane16_swap_b32 v133, v135
    s_nop 1
    buffer_store_dwordx4 v[132:135], v245, s[20:23], s39 offen
    v_pk_fma_f32 v[76:77], v[160:161], v[118:119], v[76:77] op_sel_hi:[1,0,1] neg_lo:[0,1,0] neg_hi:[0,1,0]
    v_pk_fma_f32 v[78:79], v[162:163], v[118:119], v[78:79] op_sel_hi:[1,0,1] neg_lo:[0,1,0] neg_hi:[0,1,0]
    v_pk_mul_f32 v[76:77], v[76:77], v[118:119] op_sel:[0,1] op_sel_hi:[1,1]
    v_pk_mul_f32 v[78:79], v[78:79], v[118:119] op_sel:[0,1] op_sel_hi:[1,1]
    v_cvt_pk_bf16_f32 v136, v76, v77
    v_cvt_pk_bf16_f32 v137, v78, v79
    v_pk_max_i16 v136, v136, 0
    v_pk_max_i16 v137, v137, 0
    v_pk_fma_f32 v[92:93], v[164:165], v[118:119], v[92:93] op_sel_hi:[1,0,1] neg_lo:[0,1,0] neg_hi:[0,1,0]
    v_pk_fma_f32 v[94:95], v[166:167], v[118:119], v[94:95] op_sel_hi:[1,0,1] neg_lo:[0,1,0] neg_hi:[0,1,0]
    v_pk_mul_f32 v[92:93], v[92:93], v[118:119] op_sel:[0,1] op_sel_hi:[1,1]
    v_pk_mul_f32 v[94:95], v[94:95], v[118:119] op_sel:[0,1] op_sel_hi:[1,1]
    v_cvt_pk_bf16_f32 v138, v92, v93
    v_cvt_pk_bf16_f32 v139, v94, v95
    v_pk_max_i16 v138, v138, 0
    v_pk_max_i16 v139, v139, 0
    s_add_u32 s39, s55, s58
    s_nop 0
    v_permlane16_swap_b32 v136, v138
    v_permlane16_swap_b32 v137, v139
    s_nop 1
    buffer_store_dwordx4 v[136:139], v245, s[20:23], s39 offen
    v_pk_fma_f32 v[108:109], v[168:169], v[118:119], v[108:109] op_sel_hi:[1,0,1] neg_lo:[0,1,0] neg_hi:[0,1,0]
    v_pk_fma_f32 v[110:111], v[170:171], v[118:119], v[110:111] op_sel_hi:[1,0,1] neg_lo:[0,1,0] neg_hi:[0,1,0]
    v_pk_mul_f32 v[108:109], v[108:109], v[118:119] op_sel:[0,1] op_sel_hi:[1,1]
    v_pk_mul_f32 v[110:111], v[110:111], v[118:119] op_sel:[0,1] op_sel_hi:[1,1]
    v_cvt_pk_bf16_f32 v140, v108, v109
    v_cvt_pk_bf16_f32 v141, v110, v111
    v_pk_max_i16 v140, v140, 0
    v_pk_max_i16 v141, v141, 0
    s_add_u32 s39, s55, s59
    s_nop 1
    buffer_store_dwordx2 v[140:141], v246, s[20:23], s39 offen
    s_endpgm
g1_11:
    s_mov_b32 s16, s10
    s_and_b32 s17, s11, 0xffff
    s_mov_b32 s18, 7340032
    s_mov_b32 s19, 0x20000
    v_lshrrev_b32 v236, 3, v250
    v_and_b32 v237, 7, v250
    v_xor_b32 v237, v237, v236
    s_lshl_b32 s39, s29, 8
    s_lshl_b32 s42, s28, 5
    s_add_u32 s39, s39, s42
    s_add_u32 s39, s39, 0
    v_add_u32 v238, s39, v236
    v_lshlrev_b32 v238, 11, v238
    v_lshl_add_u32 v230, v237, 4, v238
    s_mul_i32 s43, s28, 192
    s_add_u32 s39, s43, 1024
    v_add_u32 v236, s39, v250
    v_mul_u32_u24 v237, 2341, v236
    v_lshrrev_b32 v237, 16, v237
    v_mul_u32_u24 v238, 28, v237
    v_sub_u32 v238, v236, v238
    v_bfe_u32 v239, v237, 3, 1
    v_lshlrev_b32 v239, 1, v239
    v_xor_b32 v238, v238, v239
    v_lshlrev_b32 v238, 4, v238
    s_mul_i32 s39, s30, 448
    v_add_u32 v238, s39, v238
    v_mul_u32_u24 v237, 7168, v237
    v_add_u32 v231, v237, v238
    s_add_u32 s39, s43, 1088
    v_add_u32 v236, s39, v250
    v_mul_u32_u24 v237, 2341, v236
    v_lshrrev_b32 v237, 16, v237
    v_mul_u32_u24 v238, 28, v237
    v_sub_u32 v238, v236, v238
    v_bfe_u32 v239, v237, 3, 1
    v_lshlrev_b32 v239, 1, v239
    v_xor_b32 v238, v238, v239
    v_lshlrev_b32 v238, 4, v238
    s_mul_i32 s39, s30, 448
    v_add_u32 v238, s39, v238
    v_mul_u32_u24 v237, 7168, v237
    v_add_u32 v232, v237, v238
    s_add_u32 s39, s43, 1152
    v_add_u32 v236, s39, v250
    v_mul_u32_u24 v237, 2341, v236
    v_lshrrev_b32 v237, 16, v237
    v_mul_u32_u24 v238, 28, v237
    v_sub_u32 v238, v236, v238
    v_bfe_u32 v239, v237, 3, 1
    v_lshlrev_b32 v239, 1, v239
    v_xor_b32 v238, v238, v239
    v_lshlrev_b32 v238, 4, v238
    s_mul_i32 s39, s30, 448
    v_add_u32 v238, s39, v238
    v_mul_u32_u24 v237, 7168, v237
    v_add_u32 v233, v237, v238
    s_lshl_b32 s32, s29, 8
    s_and_b32 s32, s32, 0x7ff
    s_mul_i32 s33, s29, 917504
    s_mov_b32 s41, s32
    s_lshl_b32 s34, s28, 12
    s_add_u32 s34, s34, 0
    s_mul_i32 s35, s28, 3072
    s_add_u32 s35, s35, 81920
    s_mov_b32 s37, 0
    s_add_u32 m0, s34, 0
    s_add_u32 s39, s32, 0
    buffer_load_dwordx4 v230, s[96:99], s39 offen lds
    s_add_u32 m0, s34, 1024
    s_add_u32 s39, s32, 16384
    buffer_load_dwordx4 v230, s[96:99], s39 offen lds
    s_add_u32 m0, s34, 2048
    s_add_u32 s39, s32, 32768
    buffer_load_dwordx4 v230, s[96:99], s39 offen lds
    s_add_u32 m0, s34, 3072
    s_add_u32 s39, s32, 49152
    buffer_load_dwordx4 v230, s[96:99], s39 offen lds
    s_add_u32 s32, s32, 128
    s_and_b32 s32, s32, 0x7ff
    s_xor_b32 s34, s34, 16384
    s_add_u32 m0, s35, 0
    s_nop 0
    buffer_load_dwordx4 v231, s[16:19], s33 offen lds
    s_add_u32 m0, s35, 1024
    s_nop 0
    buffer_load_dwordx4 v232, s[16:19], s33 offen lds
    s_add_u32 m0, s35, 2048
    s_nop 0
    buffer_load_dwordx4 v233, s[16:19], s33 offen lds
    s_add_u32 s33, s33, 458752
    s_cmp_eq_u32 s33, 7340032
    s_cselect_b32 s33, 0, s33
    s_add_u32 s37, s37, 1
    s_add_u32 s35, s35, 28672
    s_cmp_eq_u32 s37, 3
    s_cselect_b32 s39, 86016, 0
    s_cselect_b32 s37, 0, s37
    s_sub_u32 s35, s35, s39
    s_add_u32 m0, s34, 0
    s_add_u32 s39, s32, 0
    buffer_load_dwordx4 v230, s[96:99], s39 offen lds
    s_add_u32 m0, s34, 1024
    s_add_u32 s39, s32, 16384
    buffer_load_dwordx4 v230, s[96:99], s39 offen lds
    s_add_u32 m0, s34, 2048
    s_add_u32 s39, s32, 32768
    buffer_load_dwordx4 v230, s[96:99], s39 offen lds
    s_add_u32 m0, s34, 3072
    s_add_u32 s39, s32, 49152
    buffer_load_dwordx4 v230, s[96:99], s39 offen lds
    s_add_u32 s32, s32, 128
    s_and_b32 s32, s32, 0x7ff
    s_xor_b32 s34, s34, 16384
    s_add_u32 m0, s35, 0
    s_nop 0
    buffer_load_dwordx4 v231, s[16:19], s33 offen lds
    s_add_u32 m0, s35, 1024
    s_nop 0
    buffer_load_dwordx4 v232, s[16:19], s33 offen lds
    s_add_u32 m0, s35, 2048
    s_nop 0
    buffer_load_dwordx4 v233, s[16:19], s33 offen lds
    s_add_u32 s33, s33, 458752
    s_cmp_eq_u32 s33, 7340032
    s_cselect_b32 s33, 0, s33
    s_add_u32 s37, s37, 1
    s_add_u32 s35, s35, 28672
    s_cmp_eq_u32 s37, 3
    s_cselect_b32 s39, 86016, 0
    s_cselect_b32 s37, 0, s37
    s_sub_u32 s35, s35, s39
    s_and_b32 s93, s93, 0xffff
    s_and_b32 s95, s95, 0xffff
    s_lshl_b32 s70, s2, 3
    s_add_u32 s70, s70, s24
    s_lshl_b32 s70, s70, 10
    v_lshlrev_b32 v216, 4, v250
    s_mov_b32 s71, 917504
    s_mov_b32 s91, 0
    s_add_u32 s64, s8, 29360128
    s_addc_u32 s65, s9, 0
    s_and_b32 s65, s65, 0xffff
    s_mov_b32 s66, 327680
    s_mov_b32 s67, 0x20000
    s_mov_b32 s72, s78
    s_and_b32 s73, s79, 0xffff
    s_mov_b32 s74, 256
    s_mov_b32 s75, 0x20000
    s_add_u32 s76, s30, 16
    s_mov_b32 s77, 57348
    s_lshl_b32 s39, s29, 8
    s_lshl_b32 s42, s76, 3
    s_add_u32 s39, s39, s42
    s_lshl_b32 s42, s28, 1
    s_add_u32 s91, s39, s42
    s_lshl_b32 s39, s91, 11
    buffer_load_dwordx4 v[112:115], v216, s[12:15], s39 offen offset:0
    buffer_load_dwordx4 v[116:119], v216, s[12:15], s39 offen offset:1024
    buffer_load_dwordx4 v[120:123], v216, s[12:15], s39 offen offset:2048
    buffer_load_dwordx4 v[124:127], v216, s[12:15], s39 offen offset:3072
    s_lshl_b32 s42, s27, 3
    s_add_u32 s39, s26, 2
    s_cmp_ge_u32 s39, 3
    s_cselect_b32 s43, 3, 0
    s_sub_u32 s39, s39, s43
    s_lshl_b32 s39, s39, 1
    s_add_u32 s44, s39, s42
    s_add_u32 s45, s44, 1
    s_add_u32 s39, s26, 0
    s_cmp_ge_u32 s39, 3
    s_cselect_b32 s43, 3, 0
    s_sub_u32 s39, s39, s43
    s_lshl_b32 s39, s39, 1
    s_add_u32 s46, s39, s42
    s_add_u32 s47, s46, 1
    s_add_u32 s39, s26, 1
    s_cmp_ge_u32 s39, 3
    s_cselect_b32 s43, 3, 0
    s_sub_u32 s39, s39, s43
    s_lshl_b32 s39, s39, 1
    s_add_u32 s48, s39, s42
    s_add_u32 s49, s48, 1
    s_add_u32 s50, s27, 6
    v_and_b32 v236, 7, v251
    v_xor_b32 v236, v252, v236
    v_lshlrev_b32 v236, 4, v236
    v_lshl_add_u32 v236, v251, 7, v236
    s_lshl_b32 s39, s26, 13
    s_add_u32 s39, s39, 32768
    s_lshl_b32 s42, s27, 12
    s_add_u32 s43, s39, s42
    v_add_u32 v217, s43, v236
    v_xor_b32 v218, 64, v217
    s_xor_b32 s42, s42, 4096
    s_add_u32 s43, s39, s42
    v_add_u32 v219, s43, v236
    v_xor_b32 v220, 64, v219
    v_lshrrev_b32 v236, 2, v251
    v_lshl_add_u32 v237, v252, 3, v236
    v_mul_u32_u24 v237, 448, v237
    v_and_b32 v238, 3, v250
    v_lshl_add_u32 v237, v238, 3, v237
    v_add_u32 v237, 65536, v237
    v_and_b32 v238, 1, v252
    v_xor_b32 v239, s44, v238
    v_lshl_add_u32 v221, v239, 5, v237
    v_xor_b32 v239, s45, v238
    v_lshl_add_u32 v222, v239, 5, v237
    v_xor_b32 v239, s46, v238
    v_lshl_add_u32 v223, v239, 5, v237
    v_xor_b32 v239, s47, v238
    v_lshl_add_u32 v224, v239, 5, v237
    v_xor_b32 v239, s48, v238
    v_lshl_add_u32 v225, v239, 5, v237
    v_xor_b32 v239, s49, v238
    v_lshl_add_u32 v226, v239, 5, v237
    v_xor_b32 v239, s50, v238
    v_lshl_add_u32 v227, v239, 5, v237
    v_mov_b32 v0, 0
    v_mov_b32 v1, 0
    v_mov_b32 v2, 0
    v_mov_b32 v3, 0
    v_mov_b32 v4, 0
    v_mov_b32 v5, 0
    v_mov_b32 v6, 0
    v_mov_b32 v7, 0
    v_mov_b32 v8, 0
    v_mov_b32 v9, 0
    v_mov_b32 v10, 0
    v_mov_b32 v11, 0
    v_mov_b32 v12, 0
    v_mov_b32 v13, 0
    v_mov_b32 v14, 0
    v_mov_b32 v15, 0
    v_mov_b32 v16, 0
    v_mov_b32 v17, 0
    v_mov_b32 v18, 0
    v_mov_b32 v19, 0
    v_mov_b32 v20, 0
    v_mov_b32 v21, 0
    v_mov_b32 v22, 0
    v_mov_b32 v23, 0
    v_mov_b32 v24, 0
    v_mov_b32 v25, 0
    v_mov_b32 v26, 0
    v_mov_b32 v27, 0
    v_mov_b32 v28, 0
    v_mov_b32 v29, 0
    v_mov_b32 v30, 0
    v_mov_b32 v31, 0
    v_mov_b32 v32, 0
    v_mov_b32 v33, 0
    v_mov_b32 v34, 0
    v_mov_b32 v35, 0
    v_mov_b32 v36, 0
    v_mov_b32 v37, 0
    v_mov_b32 v38, 0
    v_mov_b32 v39, 0
    v_mov_b32 v40, 0
    v_mov_b32 v41, 0
    v_mov_b32 v42, 0
    v_mov_b32 v43, 0
    v_mov_b32 v44, 0
    v_mov_b32 v45, 0
    v_mov_b32 v46, 0
    v_mov_b32 v47, 0
    v_mov_b32 v48, 0
    v_mov_b32 v49, 0
    v_mov_b32 v50, 0
    v_mov_b32 v51, 0
    v_mov_b32 v52, 0
    v_mov_b32 v53, 0
    v_mov_b32 v54, 0
    v_mov_b32 v55, 0
    v_mov_b32 v56, 0
    v_mov_b32 v57, 0
    v_mov_b32 v58, 0
    v_mov_b32 v59, 0
    v_mov_b32 v60, 0
    v_mov_b32 v61, 0
    v_mov_b32 v62, 0
    v_mov_b32 v63, 0
    v_mov_b32 v64, 0
    v_mov_b32 v65, 0
    v_mov_b32 v66, 0
    v_mov_b32 v67, 0
    v_mov_b32 v68, 0
    v_mov_b32 v69, 0
    v_mov_b32 v70, 0
    v_mov_b32 v71, 0
    v_mov_b32 v72, 0
    v_mov_b32 v73, 0
    v_mov_b32 v74, 0
    v_mov_b32 v75, 0
    v_mov_b32 v76, 0
    v_mov_b32 v77, 0
    v_mov_b32 v78, 0
    v_mov_b32 v79, 0
    v_mov_b32 v80, 0
    v_mov_b32 v81, 0
    v_mov_b32 v82, 0
    v_mov_b32 v83, 0
    v_mov_b32 v84, 0
    v_mov_b32 v85, 0
    v_mov_b32 v86, 0
    v_mov_b32 v87, 0
    v_mov_b32 v88, 0
    v_mov_b32 v89, 0
    v_mov_b32 v90, 0
    v_mov_b32 v91, 0
    v_mov_b32 v92, 0
    v_mov_b32 v93, 0
    v_mov_b32 v94, 0
    v_mov_b32 v95, 0
    v_mov_b32 v96, 0
    v_mov_b32 v97, 0
    v_mov_b32 v98, 0
    v_mov_b32 v99, 0
    v_mov_b32 v100, 0
    v_mov_b32 v101, 0
    v_mov_b32 v102, 0
    v_mov_b32 v103, 0
    v_mov_b32 v104, 0
    v_mov_b32 v105, 0
    v_mov_b32 v106, 0
    v_mov_b32 v107, 0
    v_mov_b32 v108, 0
    v_mov_b32 v109, 0
    v_mov_b32 v110, 0
    v_mov_b32 v111, 0
    v_mov_b32 v204, 0
    v_mov_b32 v205, 0
    v_mov_b32 v206, 0
    v_mov_b32 v207, 0
    v_mov_b32 v208, 0
    v_mov_b32 v209, 0
    v_mov_b32 v210, 0
    v_mov_b32 v211, 0
    v_mov_b32 v212, 0
    v_mov_b32 v213, 0
    v_mov_b32 v214, 0
    v_mov_b32 v215, 0
    v_mov_b32 v240, 0x3f803f80
    v_mov_b32 v241, 0x3f803f80
    v_mov_b32 v242, 0x3f803f80
    v_mov_b32 v243, 0x3f803f80
    s_mov_b32 s60, 28672
    s_mov_b32 s31, 0
    s_mov_b32 s38, 0
    s_waitcnt vmcnt(11)
    s_barrier
    s_waitcnt vmcnt(0)
    v_lshlrev_b32 v144, 16, v112
    v_and_b32 v145, 0xffff0000, v112
    v_lshlrev_b32 v146, 16, v113
    v_and_b32 v147, 0xffff0000, v113
    v_lshlrev_b32 v148, 16, v114
    v_and_b32 v149, 0xffff0000, v114
    v_lshlrev_b32 v150, 16, v115
    v_and_b32 v151, 0xffff0000, v115
    v_lshlrev_b32 v152, 16, v116
    v_and_b32 v153, 0xffff0000, v116
    v_lshlrev_b32 v154, 16, v117
    v_and_b32 v155, 0xffff0000, v117
    v_lshlrev_b32 v156, 16, v118
    v_and_b32 v157, 0xffff0000, v118
    v_lshlrev_b32 v158, 16, v119
    v_and_b32 v159, 0xffff0000, v119
    v_pk_add_f32 v[160:161], v[144:145], v[146:147]
    v_pk_add_f32 v[160:161], v[160:161], v[148:149]
    v_pk_add_f32 v[160:161], v[160:161], v[150:151]
    v_pk_add_f32 v[160:161], v[160:161], v[152:153]
    v_pk_add_f32 v[160:161], v[160:161], v[154:155]
    v_pk_add_f32 v[160:161], v[160:161], v[156:157]
    v_pk_add_f32 v[160:161], v[160:161], v[158:159]
    v_add_f32 v164, v160, v161
    s_nop 1
    v_add_f32_dpp v165, v164, v164 quad_perm:[1,0,3,2] row_mask:0xf bank_mask:0xf
    s_nop 1
    v_add_f32_dpp v164, v165, v165 quad_perm:[2,3,0,1] row_mask:0xf bank_mask:0xf
    s_nop 1
    v_add_f32_dpp v165, v164, v164 row_half_mirror row_mask:0xf bank_mask:0xf
    s_nop 1
    v_add_f32_dpp v164, v165, v165 row_mirror row_mask:0xf bank_mask:0xf
    v_mov_b32 v165, v164
    s_nop 1
    v_permlane16_swap_b32 v164, v165
    s_nop 1
    v_add_f32 v164, v164, v165
    v_mov_b32 v165, v164
    s_nop 1
    v_permlane32_swap_b32 v164, v165
    s_nop 1
    v_add_f32 v164, v164, v165
    v_mul_f32 v164, 0x3a800000, v164
    v_pk_add_f32 v[144:145], v[144:145], v[164:165] op_sel_hi:[1,0] neg_lo:[0,1] neg_hi:[0,1]
    v_pk_add_f32 v[146:147], v[146:147], v[164:165] op_sel_hi:[1,0] neg_lo:[0,1] neg_hi:[0,1]
    v_pk_add_f32 v[148:149], v[148:149], v[164:165] op_sel_hi:[1,0] neg_lo:[0,1] neg_hi:[0,1]
    v_pk_add_f32 v[150:151], v[150:151], v[164:165] op_sel_hi:[1,0] neg_lo:[0,1] neg_hi:[0,1]
    v_pk_add_f32 v[152:153], v[152:153], v[164:165] op_sel_hi:[1,0] neg_lo:[0,1] neg_hi:[0,1]
    v_pk_add_f32 v[154:155], v[154:155], v[164:165] op_sel_hi:[1,0] neg_lo:[0,1] neg_hi:[0,1]
    v_pk_add_f32 v[156:157], v[156:157], v[164:165] op_sel_hi:[1,0] neg_lo:[0,1] neg_hi:[0,1]
    v_pk_add_f32 v[158:159], v[158:159], v[164:165] op_sel_hi:[1,0] neg_lo:[0,1] neg_hi:[0,1]
    v_pk_mul_f32 v[160:161], v[144:145], v[144:145]
    v_pk_fma_f32 v[160:161], v[146:147], v[146:147], v[160:161]
    v_pk_fma_f32 v[160:161], v[148:149], v[148:149], v[160:161]
    v_pk_fma_f32 v[160:161], v[150:151], v[150:151], v[160:161]
    v_pk_fma_f32 v[160:161], v[152:153], v[152:153], v[160:161]
    v_pk_fma_f32 v[160:161], v[154:155], v[154:155], v[160:161]
    v_pk_fma_f32 v[160:161], v[156:157], v[156:157], v[160:161]
    v_pk_fma_f32 v[160:161], v[158:159], v[158:159], v[160:161]
    v_add_f32 v161, v160, v161
    s_nop 1
    v_add_f32_dpp v165, v161, v161 quad_perm:[1,0,3,2] row_mask:0xf bank_mask:0xf
    s_nop 1
    v_add_f32_dpp v161, v165, v165 quad_perm:[2,3,0,1] row_mask:0xf bank_mask:0xf
    s_nop 1
    v_add_f32_dpp v165, v161, v161 row_half_mirror row_mask:0xf bank_mask:0xf
    s_nop 1
    v_add_f32_dpp v161, v165, v165 row_mirror row_mask:0xf bank_mask:0xf
    v_mov_b32 v165, v161
    s_nop 1
    v_permlane16_swap_b32 v161, v165
    s_nop 1
    v_add_f32 v161, v161, v165
    v_mov_b32 v165, v161
    s_nop 1
    v_permlane32_swap_b32 v161, v165
    s_nop 1
    v_add_f32 v161, v161, v165
    v_mul_f32 v161, 0x3a800000, v161
    v_cvt_pk_bf16_f32 v165, v164, v161
    v_lshlrev_b32 v160, 16, v165
    v_and_b32 v161, 0xffff0000, v165
    v_add_f32 v161, 0x3727c5ac, v161
    v_cvt_pk_bf16_f32 v161, v161, v161
    v_and_b32 v161, 0xffff0000, v161
    v_sqrt_f32 v161, v161
    s_nop 0
    v_cvt_pk_bf16_f32 v161, v161, v161
    v_and_b32 v161, 0xffff0000, v161
    v_rcp_f32 v161, v161
    s_nop 0
    v_lshlrev_b32 v144, 16, v120
    v_and_b32 v145, 0xffff0000, v120
    v_lshlrev_b32 v146, 16, v121
    v_and_b32 v147, 0xffff0000, v121
    v_lshlrev_b32 v148, 16, v122
    v_and_b32 v149, 0xffff0000, v122
    v_lshlrev_b32 v150, 16, v123
    v_and_b32 v151, 0xffff0000, v123
    v_lshlrev_b32 v152, 16, v124
    v_and_b32 v153, 0xffff0000, v124
    v_lshlrev_b32 v154, 16, v125
    v_and_b32 v155, 0xffff0000, v125
    v_lshlrev_b32 v156, 16, v126
    v_and_b32 v157, 0xffff0000, v126
    v_lshlrev_b32 v158, 16, v127
    v_and_b32 v159, 0xffff0000, v127
    v_pk_add_f32 v[162:163], v[144:145], v[146:147]
    v_pk_add_f32 v[162:163], v[162:163], v[148:149]
    v_pk_add_f32 v[162:163], v[162:163], v[150:151]
    v_pk_add_f32 v[162:163], v[162:163], v[152:153]
    v_pk_add_f32 v[162:163], v[162:163], v[154:155]
    v_pk_add_f32 v[162:163], v[162:163], v[156:157]
    v_pk_add_f32 v[162:163], v[162:163], v[158:159]
    v_add_f32 v164, v162, v163
    s_nop 1
    v_add_f32_dpp v165, v164, v164 quad_perm:[1,0,3,2] row_mask:0xf bank_mask:0xf
    s_nop 1
    v_add_f32_dpp v164, v165, v165 quad_perm:[2,3,0,1] row_mask:0xf bank_mask:0xf
    s_nop 1
    v_add_f32_dpp v165, v164, v164 row_half_mirror row_mask:0xf bank_mask:0xf
    s_nop 1
    v_add_f32_dpp v164, v165, v165 row_mirror row_mask:0xf bank_mask:0xf
    v_mov_b32 v165, v164
    s_nop 1
    v_permlane16_swap_b32 v164, v165
    s_nop 1
    v_add_f32 v164, v164, v165
    v_mov_b32 v165, v164
    s_nop 1
    v_permlane32_swap_b32 v164, v165
    s_nop 1
    v_add_f32 v164, v164, v165
    v_mul_f32 v164, 0x3a800000, v164
    v_pk_add_f32 v[144:145], v[144:145], v[164:165] op_sel_hi:[1,0] neg_lo:[0,1] neg_hi:[0,1]
    v_pk_add_f32 v[146:147], v[146:147], v[164:165] op_sel_hi:[1,0] neg_lo:[0,1] neg_hi:[0,1]
    v_pk_add_f32 v[148:149], v[148:149], v[164:165] op_sel_hi:[1,0] neg_lo:[0,1] neg_hi:[0,1]
    v_pk_add_f32 v[150:151], v[150:151], v[164:165] op_sel_hi:[1,0] neg_lo:[0,1] neg_hi:[0,1]
    v_pk_add_f32 v[152:153], v[152:153], v[164:165] op_sel_hi:[1,0] neg_lo:[0,1] neg_hi:[0,1]
    v_pk_add_f32 v[154:155], v[154:155], v[164:165] op_sel_hi:[1,0] neg_lo:[0,1] neg_hi:[0,1]
    v_pk_add_f32 v[156:157], v[156:157], v[164:165] op_sel_hi:[1,0] neg_lo:[0,1] neg_hi:[0,1]
    v_pk_add_f32 v[158:159], v[158:159], v[164:165] op_sel_hi:[1,0] neg_lo:[0,1] neg_hi:[0,1]
    v_pk_mul_f32 v[162:163], v[144:145], v[144:145]
    v_pk_fma_f32 v[162:163], v[146:147], v[146:147], v[162:163]
    v_pk_fma_f32 v[162:163], v[148:149], v[148:149], v[162:163]
    v_pk_fma_f32 v[162:163], v[150:151], v[150:151], v[162:163]
    v_pk_fma_f32 v[162:163], v[152:153], v[152:153], v[162:163]
    v_pk_fma_f32 v[162:163], v[154:155], v[154:155], v[162:163]
    v_pk_fma_f32 v[162:163], v[156:157], v[156:157], v[162:163]
    v_pk_fma_f32 v[162:163], v[158:159], v[158:159], v[162:163]
    v_add_f32 v163, v162, v163
    s_nop 1
    v_add_f32_dpp v165, v163, v163 quad_perm:[1,0,3,2] row_mask:0xf bank_mask:0xf
    s_nop 1
    v_add_f32_dpp v163, v165, v165 quad_perm:[2,3,0,1] row_mask:0xf bank_mask:0xf
    s_nop 1
    v_add_f32_dpp v165, v163, v163 row_half_mirror row_mask:0xf bank_mask:0xf
    s_nop 1
    v_add_f32_dpp v163, v165, v165 row_mirror row_mask:0xf bank_mask:0xf
    v_mov_b32 v165, v163
    s_nop 1
    v_permlane16_swap_b32 v163, v165
    s_nop 1
    v_add_f32 v163, v163, v165
    v_mov_b32 v165, v163
    s_nop 1
    v_permlane32_swap_b32 v163, v165
    s_nop 1
    v_add_f32 v163, v163, v165
    v_mul_f32 v163, 0x3a800000, v163
    v_cvt_pk_bf16_f32 v165, v164, v163
    v_lshlrev_b32 v162, 16, v165
    v_and_b32 v163, 0xffff0000, v165
    v_add_f32 v163, 0x3727c5ac, v163
    v_cvt_pk_bf16_f32 v163, v163, v163
    v_and_b32 v163, 0xffff0000, v163
    v_sqrt_f32 v163, v163
    s_nop 0
    v_cvt_pk_bf16_f32 v163, v163, v163
    v_and_b32 v163, 0xffff0000, v163
    v_rcp_f32 v163, v163
    s_nop 0
    v_lshlrev_b32 v164, 24, v250
    s_lshl_b32 s39, s91, 3
    buffer_store_dwordx4 v[160:163], v164, s[64:67], s39 offen sc0 sc1
    s_barrier
    s_mov_b32 s25, s34
    s_mov_b32 s3, s35
.p2align 6
g1_11_loop:
    ds_read_b128 v[112:115], v217 offset:0
    ds_read_b128 v[120:123], v217 offset:2048
    s_add_u32 m0, s25, 0
    s_add_u32 s39, s32, 0
    buffer_load_dwordx4 v230, s[96:99], s39 offen lds
    ds_read_b128 v[128:131], v219 offset:0
    ds_read_b128 v[136:139], v219 offset:2048
    ds_read_b64_tr_b16 v[144:145], v221 offset:0
    ds_read_b64_tr_b16 v[146:147], v221 offset:1792
    ds_read_b64_tr_b16 v[152:153], v222 offset:0
    s_add_u32 m0, s25, 1024
    s_add_u32 s39, s32, 16384
    buffer_load_dwordx4 v230, s[96:99], s39 offen lds
    ds_read_b64_tr_b16 v[154:155], v222 offset:1792
    ds_read_b64_tr_b16 v[160:161], v223 offset:0
    ds_read_b64_tr_b16 v[162:163], v223 offset:1792
    ds_read_b64_tr_b16 v[168:169], v224 offset:0
    ds_read_b64_tr_b16 v[170:171], v224 offset:1792
    s_add_u32 m0, s25, 2048
    s_add_u32 s39, s32, 32768
    buffer_load_dwordx4 v230, s[96:99], s39 offen lds
    ds_read_b64_tr_b16 v[176:177], v225 offset:0
    ds_read_b64_tr_b16 v[178:179], v225 offset:1792
    ds_read_b64_tr_b16 v[184:185], v226 offset:0
    ds_read_b64_tr_b16 v[186:187], v226 offset:1792
    ds_read_b64_tr_b16 v[192:193], v227 offset:0
    s_add_u32 m0, s25, 3072
    s_add_u32 s39, s32, 49152
    buffer_load_dwordx4 v230, s[96:99], s39 offen lds
    ds_read_b64_tr_b16 v[194:195], v227 offset:1792
    ds_read_b128 v[116:119], v218 offset:0
    ds_read_b128 v[124:127], v218 offset:2048
    ds_read_b128 v[132:135], v220 offset:0
    ds_read_b128 v[140:143], v220 offset:2048
    s_add_u32 m0, s3, 0
    s_nop 0
    buffer_load_dwordx4 v231, s[16:19], s33 offen lds
    ds_read_b64_tr_b16 v[148:149], v221 offset:14336
    ds_read_b64_tr_b16 v[150:151], v221 offset:16128
    ds_read_b64_tr_b16 v[156:157], v222 offset:14336
    ds_read_b64_tr_b16 v[158:159], v222 offset:16128
    ds_read_b64_tr_b16 v[164:165], v223 offset:14336
    s_add_u32 m0, s3, 1024
    s_nop 0
    buffer_load_dwordx4 v232, s[16:19], s33 offen lds
    ds_read_b64_tr_b16 v[166:167], v223 offset:16128
    ds_read_b64_tr_b16 v[172:173], v224 offset:14336
    ds_read_b64_tr_b16 v[174:175], v224 offset:16128
    ds_read_b64_tr_b16 v[180:181], v225 offset:14336
    ds_read_b64_tr_b16 v[182:183], v225 offset:16128
    s_add_u32 m0, s3, 2048
    s_nop 0
    buffer_load_dwordx4 v233, s[16:19], s33 offen lds
    ds_read_b64_tr_b16 v[188:189], v226 offset:14336
    ds_read_b64_tr_b16 v[190:191], v226 offset:16128
    ds_read_b64_tr_b16 v[196:197], v227 offset:14336
    ds_read_b64_tr_b16 v[198:199], v227 offset:16128
    s_bitcmp1_b32 s77, s31
    s_cbranch_scc1 g1_11_event
    s_waitcnt vmcnt(7) lgkmcnt(0)
g1_11_afterwait:
    s_barrier
    s_setprio 1
    v_mfma_f32_16x16x32_bf16 v[0:3], v[144:147], v[112:115], v[0:3]
    v_mfma_f32_16x16x32_bf16 v[4:7], v[144:147], v[120:123], v[4:7]
    v_mfma_f32_16x16x32_bf16 v[8:11], v[144:147], v[128:131], v[8:11]
    s_add_u32 s32, s32, 128
    v_mfma_f32_16x16x32_bf16 v[12:15], v[144:147], v[136:139], v[12:15]
    s_and_b32 s32, s32, 0x7ff
    v_mfma_f32_16x16x32_bf16 v[16:19], v[152:155], v[112:115], v[16:19]
    s_xor_b32 s34, s34, 16384
    v_mfma_f32_16x16x32_bf16 v[20:23], v[152:155], v[120:123], v[20:23]
    s_cmp_ge_u32 s31, 13
    v_mfma_f32_16x16x32_bf16 v[24:27], v[152:155], v[128:131], v[24:27]
    s_cselect_b32 s98, 0, s98
    v_mfma_f32_16x16x32_bf16 v[28:31], v[152:155], v[136:139], v[28:31]
    s_cselect_b32 s25, 163840, s34
    v_mfma_f32_16x16x32_bf16 v[32:35], v[160:163], v[112:115], v[32:35]
    s_add_u32 s41, s41, 128
    v_mfma_f32_16x16x32_bf16 v[36:39], v[160:163], v[120:123], v[36:39]
    s_and_b32 s41, s41, 0x7ff
    v_mfma_f32_16x16x32_bf16 v[40:43], v[160:163], v[128:131], v[40:43]
    s_add_u32 s91, s91, s71
    v_mfma_f32_16x16x32_bf16 v[44:47], v[160:163], v[136:139], v[44:47]
    s_add_u32 s33, s33, 458752
    v_mfma_f32_16x16x32_bf16 v[48:51], v[168:171], v[112:115], v[48:51]
    s_cmp_eq_u32 s33, 7340032
    v_mfma_f32_16x16x32_bf16 v[52:55], v[168:171], v[120:123], v[52:55]
    s_cselect_b32 s33, 0, s33
    v_mfma_f32_16x16x32_bf16 v[56:59], v[168:171], v[128:131], v[56:59]
    s_add_u32 s37, s37, 1
    v_mfma_f32_16x16x32_bf16 v[60:63], v[168:171], v[136:139], v[60:63]
    s_add_u32 s35, s35, 28672
    v_mfma_f32_16x16x32_bf16 v[64:67], v[176:179], v[112:115], v[64:67]
    s_cmp_eq_u32 s37, 3
    v_mfma_f32_16x16x32_bf16 v[68:71], v[176:179], v[120:123], v[68:71]
    s_cselect_b32 s39, 86016, 0
    v_mfma_f32_16x16x32_bf16 v[72:75], v[176:179], v[128:131], v[72:75]
    s_cselect_b32 s37, 0, s37
    v_mfma_f32_16x16x32_bf16 v[76:79], v[176:179], v[136:139], v[76:79]
    s_sub_u32 s35, s35, s39
    v_mfma_f32_16x16x32_bf16 v[80:83], v[184:187], v[112:115], v[80:83]
    s_cmp_ge_u32 s31, 13
    v_mfma_f32_16x16x32_bf16 v[84:87], v[184:187], v[120:123], v[84:87]
    s_cselect_b32 s3, 163840, s35
    v_mfma_f32_16x16x32_bf16 v[88:91], v[184:187], v[128:131], v[88:91]
    s_cselect_b32 s18, 0, s18
    v_mfma_f32_16x16x32_bf16 v[92:95], v[184:187], v[136:139], v[92:95]
    s_cselect_b32 s14, 0, s14
    v_mfma_f32_16x16x32_bf16 v[96:99], v[192:195], v[112:115], v[96:99]
    s_add_u32 s38, s38, 1
    v_mfma_f32_16x16x32_bf16 v[100:103], v[192:195], v[120:123], v[100:103]
    s_cmp_eq_u32 s38, 3
    v_mfma_f32_16x16x32_bf16 v[104:107], v[192:195], v[128:131], v[104:107]
    s_cselect_b32 s36, 4294909952, s60
    v_mfma_f32_16x16x32_bf16 v[108:111], v[192:195], v[136:139], v[108:111]
    s_cselect_b32 s38, 0, s38
    v_mfma_f32_16x16x32_bf16 v[0:3], v[148:151], v[116:119], v[0:3]
    v_xor_b32 v217, 16384, v217
    v_mfma_f32_16x16x32_bf16 v[4:7], v[148:151], v[124:127], v[4:7]
    v_xor_b32 v218, 16384, v218
    v_mfma_f32_16x16x32_bf16 v[8:11], v[148:151], v[132:135], v[8:11]
    v_xor_b32 v219, 16384, v219
    v_mfma_f32_16x16x32_bf16 v[12:15], v[148:151], v[140:143], v[12:15]
    v_xor_b32 v220, 16384, v220
    v_mfma_f32_16x16x32_bf16 v[16:19], v[156:159], v[116:119], v[16:19]
    v_add_u32 v221, s36, v221
    v_mfma_f32_16x16x32_bf16 v[20:23], v[156:159], v[124:127], v[20:23]
    v_add_u32 v222, s36, v222
    v_mfma_f32_16x16x32_bf16 v[24:27], v[156:159], v[132:135], v[24:27]
    v_add_u32 v223, s36, v223
    v_mfma_f32_16x16x32_bf16 v[28:31], v[156:159], v[140:143], v[28:31]
    v_add_u32 v224, s36, v224
    v_mfma_f32_16x16x32_bf16 v[32:35], v[164:167], v[116:119], v[32:35]
    v_add_u32 v225, s36, v225
    v_mfma_f32_16x16x32_bf16 v[36:39], v[164:167], v[124:127], v[36:39]
    v_add_u32 v226, s36, v226
    v_mfma_f32_16x16x32_bf16 v[40:43], v[164:167], v[132:135], v[40:43]
    v_add_u32 v227, s36, v227
    v_mfma_f32_16x16x32_bf16 v[44:47], v[164:167], v[140:143], v[44:47]
    v_mfma_f32_16x16x32_bf16 v[48:51], v[172:175], v[116:119], v[48:51]
    v_mfma_f32_16x16x32_bf16 v[52:55], v[172:175], v[124:127], v[52:55]
    v_mfma_f32_16x16x32_bf16 v[56:59], v[172:175], v[132:135], v[56:59]
    v_mfma_f32_16x16x32_bf16 v[60:63], v[172:175], v[140:143], v[60:63]
    v_mfma_f32_16x16x32_bf16 v[64:67], v[180:183], v[116:119], v[64:67]
    v_mfma_f32_16x16x32_bf16 v[68:71], v[180:183], v[124:127], v[68:71]
    v_mfma_f32_16x16x32_bf16 v[72:75], v[180:183], v[132:135], v[72:75]
    v_mfma_f32_16x16x32_bf16 v[76:79], v[180:183], v[140:143], v[76:79]
    v_mfma_f32_16x16x32_bf16 v[80:83], v[188:191], v[116:119], v[80:83]
    v_mfma_f32_16x16x32_bf16 v[84:87], v[188:191], v[124:127], v[84:87]
    v_mfma_f32_16x16x32_bf16 v[88:91], v[188:191], v[132:135], v[88:91]
    v_mfma_f32_16x16x32_bf16 v[92:95], v[188:191], v[140:143], v[92:95]
    v_mfma_f32_16x16x32_bf16 v[96:99], v[196:199], v[116:119], v[96:99]
    v_mfma_f32_16x16x32_bf16 v[100:103], v[196:199], v[124:127], v[100:103]
    v_mfma_f32_16x16x32_bf16 v[104:107], v[196:199], v[132:135], v[104:107]
    v_mfma_f32_16x16x32_bf16 v[108:111], v[196:199], v[140:143], v[108:111]
    s_cmp_lt_u32 s31, 2
    s_cbranch_scc0 g1_11_nocs
    v_mfma_f32_16x16x32_bf16 v[204:207], v[144:147], v[240:243], v[204:207]
    v_mfma_f32_16x16x32_bf16 v[208:211], v[152:155], v[240:243], v[208:211]
    v_mfma_f32_16x16x32_bf16 v[212:215], v[192:195], v[240:243], v[212:215]
    v_mfma_f32_16x16x32_bf16 v[204:207], v[148:151], v[240:243], v[204:207]
    v_mfma_f32_16x16x32_bf16 v[208:211], v[156:159], v[240:243], v[208:211]
    v_mfma_f32_16x16x32_bf16 v[212:215], v[196:199], v[240:243], v[212:215]
g1_11_nocs:
    s_setprio 0
    s_add_u32 s31, s31, 1
    s_cmp_lt_u32 s31, 16
    s_cbranch_scc0 g1_11_post
    s_barrier
    s_branch g1_11_loop
g1_11_event:
    s_cmp_eq_u32 s31, 15
    s_cbranch_scc0 g1_11_evn15
    s_waitcnt vmcnt(19) lgkmcnt(0)
    s_branch g1_11_afterwait
g1_11_evn15:
    s_cmp_eq_u32 s31, 2
    s_cbranch_scc1 g1_11_ev2
    s_cmp_eq_u32 s31, 14
    s_cbranch_scc1 g1_11_evw
    s_mov_b32 s64, s92
    s_mov_b32 s65, s93
    s_mov_b32 s66, 2097152
    s_mov_b32 s72, s94
    s_mov_b32 s73, s95
    s_mov_b32 s74, 7340032
    s_mov_b32 s67, 0x20000
    s_mov_b32 s75, 0x20000
    s_lshl_b32 s39, s70, 2
    buffer_load_dwordx4 v[212:215], v216, s[64:67], s70 offen
    buffer_load_dwordx4 v[212:215], v216, s[72:75], s39 offen offset:0
    buffer_load_dwordx4 v[212:215], v216, s[72:75], s39 offen offset:1024
    buffer_load_dwordx4 v[212:215], v216, s[72:75], s39 offen offset:2048
    buffer_load_dwordx4 v[212:215], v216, s[72:75], s39 offen offset:3072
g1_11_evw:
    s_waitcnt vmcnt(12) lgkmcnt(0)
    s_branch g1_11_afterwait
g1_11_ev2:
    v_lshlrev_b32 v236, 24, v251
    v_lshl_add_u32 v236, v252, 4, v236
    s_lshl_b32 s42, s76, 3
    s_add_u32 s42, s42, s29
    s_lshl_b32 s42, s42, 10
    s_add_u32 s42, s42, 65536
    s_lshl_b32 s39, s44, 6
    s_add_u32 s39, s39, s42
    buffer_store_dwordx4 v[204:207], v236, s[64:67], s39 offen sc0 sc1
    s_lshl_b32 s39, s45, 6
    s_add_u32 s39, s39, s42
    buffer_store_dwordx4 v[208:211], v236, s[64:67], s39 offen sc0 sc1
    s_lshl_b32 s39, s50, 6
    s_add_u32 s39, s39, s42
    buffer_store_dwordx4 v[212:215], v236, s[64:67], s39 offen sc0 sc1
    s_waitcnt vmcnt(10) lgkmcnt(0)
    s_branch g1_11_afterwait
g1_11_post:
g1_11_red:
    s_barrier
    v_mov_b32 v236, 163712
    ds_read_b32 v237, v236
    s_waitcnt lgkmcnt(0)
    v_readfirstlane_b32 s39, v237
    s_nop 3
    s_cmp_eq_u32 s39, 0
    s_cbranch_scc1 g1_11_fast
    s_barrier
    s_mov_b32 s14, 4194304
    s_mov_b32 s18, 7340032
    s_mov_b32 s31, s24
g1_11_slow1:
    s_lshl_b32 s39, s29, 8
    s_add_u32 s39, s39, s31
    s_sub_u32 s39, s39, 16
    s_max_i32 s39, s39, 0
    s_lshl_b32 s39, s39, 11
    buffer_load_dwordx4 v[112:115], v216, s[12:15], s39 offen
    buffer_load_dwordx4 v[116:119], v216, s[12:15], s39 offen offset:1024
    s_waitcnt vmcnt(0)
    v_lshlrev_b32 v144, 16, v112
    v_and_b32 v145, 0xffff0000, v112
    v_lshlrev_b32 v146, 16, v113
    v_and_b32 v147, 0xffff0000, v113
    v_lshlrev_b32 v148, 16, v114
    v_and_b32 v149, 0xffff0000, v114
    v_lshlrev_b32 v150, 16, v115
    v_and_b32 v151, 0xffff0000, v115
    v_lshlrev_b32 v152, 16, v116
    v_and_b32 v153, 0xffff0000, v116
    v_lshlrev_b32 v154, 16, v117
    v_and_b32 v155, 0xffff0000, v117
    v_lshlrev_b32 v156, 16, v118
    v_and_b32 v157, 0xffff0000, v118
    v_lshlrev_b32 v158, 16, v119
    v_and_b32 v159, 0xffff0000, v119
    v_pk_add_f32 v[160:161], v[144:145], v[146:147]
    v_pk_add_f32 v[160:161], v[160:161], v[148:149]
    v_pk_add_f32 v[160:161], v[160:161], v[150:151]
    v_pk_add_f32 v[160:161], v[160:161], v[152:153]
    v_pk_add_f32 v[160:161], v[160:161], v[154:155]
    v_pk_add_f32 v[160:161], v[160:161], v[156:157]
    v_pk_add_f32 v[160:161], v[160:161], v[158:159]
    v_add_f32 v164, v160, v161
    s_nop 1
    v_add_f32_dpp v165, v164, v164 quad_perm:[1,0,3,2] row_mask:0xf bank_mask:0xf
    s_nop 1
    v_add_f32_dpp v164, v165, v165 quad_perm:[2,3,0,1] row_mask:0xf bank_mask:0xf
    s_nop 1
    v_add_f32_dpp v165, v164, v164 row_half_mirror row_mask:0xf bank_mask:0xf
    s_nop 1
    v_add_f32_dpp v164, v165, v165 row_mirror row_mask:0xf bank_mask:0xf
    v_mov_b32 v165, v164
    s_nop 1
    v_permlane16_swap_b32 v164, v165
    s_nop 1
    v_add_f32 v164, v164, v165
    v_mov_b32 v165, v164
    s_nop 1
    v_permlane32_swap_b32 v164, v165
    s_nop 1
    v_add_f32 v164, v164, v165
    v_mul_f32 v164, 0x3a800000, v164
    v_pk_add_f32 v[144:145], v[144:145], v[164:165] op_sel_hi:[1,0] neg_lo:[0,1] neg_hi:[0,1]
    v_pk_add_f32 v[146:147], v[146:147], v[164:165] op_sel_hi:[1,0] neg_lo:[0,1] neg_hi:[0,1]
    v_pk_add_f32 v[148:149], v[148:149], v[164:165] op_sel_hi:[1,0] neg_lo:[0,1] neg_hi:[0,1]
    v_pk_add_f32 v[150:151], v[150:151], v[164:165] op_sel_hi:[1,0] neg_lo:[0,1] neg_hi:[0,1]
    v_pk_add_f32 v[152:153], v[152:153], v[164:165] op_sel_hi:[1,0] neg_lo:[0,1] neg_hi:[0,1]
    v_pk_add_f32 v[154:155], v[154:155], v[164:165] op_sel_hi:[1,0] neg_lo:[0,1] neg_hi:[0,1]
    v_pk_add_f32 v[156:157], v[156:157], v[164:165] op_sel_hi:[1,0] neg_lo:[0,1] neg_hi:[0,1]
    v_pk_add_f32 v[158:159], v[158:159], v[164:165] op_sel_hi:[1,0] neg_lo:[0,1] neg_hi:[0,1]
    v_pk_mul_f32 v[160:161], v[144:145], v[144:145]
    v_pk_fma_f32 v[160:161], v[146:147], v[146:147], v[160:161]
    v_pk_fma_f32 v[160:161], v[148:149], v[148:149], v[160:161]
    v_pk_fma_f32 v[160:161], v[150:151], v[150:151], v[160:161]
    v_pk_fma_f32 v[160:161], v[152:153], v[152:153], v[160:161]
    v_pk_fma_f32 v[160:161], v[154:155], v[154:155], v[160:161]
    v_pk_fma_f32 v[160:161], v[156:157], v[156:157], v[160:161]
    v_pk_fma_f32 v[160:161], v[158:159], v[158:159], v[160:161]
    v_add_f32 v161, v160, v161
    s_nop 1
    v_add_f32_dpp v165, v161, v161 quad_perm:[1,0,3,2] row_mask:0xf bank_mask:0xf
    s_nop 1
    v_add_f32_dpp v161, v165, v165 quad_perm:[2,3,0,1] row_mask:0xf bank_mask:0xf
    s_nop 1
    v_add_f32_dpp v165, v161, v161 row_half_mirror row_mask:0xf bank_mask:0xf
    s_nop 1
    v_add_f32_dpp v161, v165, v165 row_mirror row_mask:0xf bank_mask:0xf
    v_mov_b32 v165, v161
    s_nop 1
    v_permlane16_swap_b32 v161, v165
    s_nop 1
    v_add_f32 v161, v161, v165
    v_mov_b32 v165, v161
    s_nop 1
    v_permlane32_swap_b32 v161, v165
    s_nop 1
    v_add_f32 v161, v161, v165
    v_mul_f32 v161, 0x3a800000, v161
    v_cvt_pk_bf16_f32 v165, v164, v161
    v_lshlrev_b32 v160, 16, v165
    v_and_b32 v161, 0xffff0000, v165
    v_add_f32 v161, 0x3727c5ac, v161
    v_cvt_pk_bf16_f32 v161, v161, v161
    v_and_b32 v161, 0xffff0000, v161
    v_sqrt_f32 v161, v161
    s_nop 0
    v_cvt_pk_bf16_f32 v161, v161, v161
    v_and_b32 v161, 0xffff0000, v161
    v_rcp_f32 v161, v161
    s_nop 0
    s_lshl_b32 s39, s31, 3
    s_add_u32 s39, s39, 151552
    v_mov_b32 v236, s39
    ds_write_b64 v236, v[160:161]
    s_add_u32 s31, s31, 8
    s_cmp_lt_u32 s31, 272
    s_cbranch_scc1 g1_11_slow1
    v_min_u32 v236, 27, v250
    s_mul_i32 s39, s30, 448
    v_lshl_add_u32 v239, v236, 4, s39
    v_mov_b32 v144, 0
    v_mov_b32 v145, 0
    v_mov_b32 v146, 0
    v_mov_b32 v147, 0
    v_mov_b32 v148, 0
    v_mov_b32 v149, 0
    v_mov_b32 v150, 0
    v_mov_b32 v151, 0
    s_mul_i32 s39, s24, 917504
    s_mov_b32 s31, 0
g1_11_slow2:
    buffer_load_dwordx4 v[112:115], v239, s[16:19], s39 offen
    s_add_u32 s39, s39, 7168
    s_add_u32 s31, s31, 1
    s_waitcnt vmcnt(0)
    v_lshlrev_b32 v116, 16, v112
    v_and_b32 v117, 0xffff0000, v112
    v_pk_add_f32 v[144:145], v[144:145], v[116:117]
    v_lshlrev_b32 v116, 16, v113
    v_and_b32 v117, 0xffff0000, v113
    v_pk_add_f32 v[146:147], v[146:147], v[116:117]
    v_lshlrev_b32 v116, 16, v114
    v_and_b32 v117, 0xffff0000, v114
    v_pk_add_f32 v[148:149], v[148:149], v[116:117]
    v_lshlrev_b32 v116, 16, v115
    v_and_b32 v117, 0xffff0000, v115
    v_pk_add_f32 v[150:151], v[150:151], v[116:117]
    s_cmp_lt_u32 s31, 128
    s_cbranch_scc1 g1_11_slow2
    s_lshl_b32 s39, s24, 10
    s_add_u32 s39, s39, 154624
    v_lshl_add_u32 v236, v236, 5, s39
    ds_write_b128 v236, v[144:147]
    ds_write_b128 v236, v[148:151] offset:16
    v_mov_b32 v236, 163712
    v_mov_b32 v237, 0
    ds_write_b32 v236, v237
    s_waitcnt lgkmcnt(0)
    s_barrier
    s_branch g1_11_red
g1_11_fast:
    s_lshl_b32 s39, s26, 6
    s_lshl_b32 s42, s27, 5
    s_xor_b32 s42, s42, 0
    s_add_u32 s39, s39, s42
    s_add_u32 s52, s39, 128
    s_lshl_b32 s39, s26, 6
    s_lshl_b32 s42, s27, 5
    s_xor_b32 s42, s42, 16
    s_add_u32 s39, s39, s42
    s_add_u32 s53, s39, 128
    s_lshl_b32 s39, s26, 6
    s_lshl_b32 s42, s27, 5
    s_xor_b32 s42, s42, 32
    s_add_u32 s39, s39, s42
    s_add_u32 s54, s39, 128
    s_lshl_b32 s39, s26, 6
    s_lshl_b32 s42, s27, 5
    s_xor_b32 s42, s42, 48
    s_add_u32 s39, s39, s42
    s_add_u32 s55, s39, 128
    s_add_u32 s39, s52, 18960
    v_add_u32 v240, s39, v251
    v_lshlrev_b32 v240, 3, v240
    ds_read_b64 v[112:113], v240
    s_add_u32 s39, s53, 18960
    v_add_u32 v240, s39, v251
    v_lshlrev_b32 v240, 3, v240
    ds_read_b64 v[114:115], v240
    s_add_u32 s39, s54, 18960
    v_add_u32 v240, s39, v251
    v_lshlrev_b32 v240, 3, v240
    ds_read_b64 v[116:117], v240
    s_add_u32 s39, s55, 18960
    v_add_u32 v240, s39, v251
    v_lshlrev_b32 v240, 3, v240
    ds_read_b64 v[118:119], v240
    s_lshl_b32 s39, s44, 6
    s_add_u32 s39, s39, 162816
    v_lshl_add_u32 v240, v252, 4, s39
    ds_read_b128 v[144:147], v240
    s_lshl_b32 s39, s45, 6
    s_add_u32 s39, s39, 162816
    v_lshl_add_u32 v240, v252, 4, s39
    ds_read_b128 v[148:151], v240
    s_lshl_b32 s39, s46, 6
    s_add_u32 s39, s39, 162816
    v_lshl_add_u32 v240, v252, 4, s39
    ds_read_b128 v[152:155], v240
    s_lshl_b32 s39, s47, 6
    s_add_u32 s39, s39, 162816
    v_lshl_add_u32 v240, v252, 4, s39
    ds_read_b128 v[156:159], v240
    s_lshl_b32 s39, s48, 6
    s_add_u32 s39, s39, 162816
    v_lshl_add_u32 v240, v252, 4, s39
    ds_read_b128 v[160:163], v240
    s_lshl_b32 s39, s49, 6
    s_add_u32 s39, s39, 162816
    v_lshl_add_u32 v240, v252, 4, s39
    ds_read_b128 v[164:167], v240
    s_lshl_b32 s39, s50, 6
    s_add_u32 s39, s39, 162816
    v_lshl_add_u32 v240, v252, 4, s39
    ds_read_b128 v[168:171], v240
    s_waitcnt lgkmcnt(0)
    v_and_b32 v236, 1, v252
    v_lshrrev_b32 v237, 1, v252
    v_lshl_or_b32 v244, v236, 1, v237
    v_lshl_add_u32 v245, v244, 4, v251
    v_lshlrev_b32 v245, 4, v245
    s_lshl_b32 s39, s27, 1
    v_add_u32 v237, s39, v237
    v_lshl_add_u32 v246, v237, 4, v251
    v_lshlrev_b32 v246, 4, v246
    v_lshl_add_u32 v246, v236, 3, v246
    s_lshr_b32 s39, s52, 4
    s_lshl_b32 s42, s29, 4
    s_add_u32 s39, s39, s42
    s_mul_i32 s52, s39, 147456
    s_lshr_b32 s39, s53, 4
    s_lshl_b32 s42, s29, 4
    s_add_u32 s39, s39, s42
    s_mul_i32 s53, s39, 147456
    s_lshr_b32 s39, s54, 4
    s_lshl_b32 s42, s29, 4
    s_add_u32 s39, s39, s42
    s_mul_i32 s54, s39, 147456
    s_lshr_b32 s39, s55, 4
    s_lshl_b32 s42, s29, 4
    s_add_u32 s39, s39, s42
    s_mul_i32 s55, s39, 147456
    s_mul_i32 s42, s30, 7
    s_add_u32 s42, s42, 32
    s_lshr_b32 s39, s44, 1
    s_add_u32 s39, s39, s42
    s_lshl_b32 s56, s39, 10
    s_lshr_b32 s39, s46, 1
    s_add_u32 s39, s39, s42
    s_lshl_b32 s57, s39, 10
    s_lshr_b32 s39, s48, 1
    s_add_u32 s39, s39, s42
    s_lshl_b32 s58, s39, 10
    s_lshr_b32 s39, s50, 1
    s_add_u32 s39, s39, s42
    s_lshl_b32 s59, s39, 10
    v_pk_fma_f32 v[0:1], v[144:145], v[112:113], v[0:1] op_sel_hi:[1,0,1] neg_lo:[0,1,0] neg_hi:[0,1,0]
    v_pk_fma_f32 v[2:3], v[146:147], v[112:113], v[2:3] op_sel_hi:[1,0,1] neg_lo:[0,1,0] neg_hi:[0,1,0]
    v_pk_mul_f32 v[0:1], v[0:1], v[112:113] op_sel:[0,1] op_sel_hi:[1,1]
    v_pk_mul_f32 v[2:3], v[2:3], v[112:113] op_sel:[0,1] op_sel_hi:[1,1]
    v_cvt_pk_bf16_f32 v128, v0, v1
    v_cvt_pk_bf16_f32 v129, v2, v3
    v_pk_max_i16 v128, v128, 0
    v_pk_max_i16 v129, v129, 0
    v_pk_fma_f32 v[16:17], v[148:149], v[112:113], v[16:17] op_sel_hi:[1,0,1] neg_lo:[0,1,0] neg_hi:[0,1,0]
    v_pk_fma_f32 v[18:19], v[150:151], v[112:113], v[18:19] op_sel_hi:[1,0,1] neg_lo:[0,1,0] neg_hi:[0,1,0]
    v_pk_mul_f32 v[16:17], v[16:17], v[112:113] op_sel:[0,1] op_sel_hi:[1,1]
    v_pk_mul_f32 v[18:19], v[18:19], v[112:113] op_sel:[0,1] op_sel_hi:[1,1]
    v_cvt_pk_bf16_f32 v130, v16, v17
    v_cvt_pk_bf16_f32 v131, v18, v19
    v_pk_max_i16 v130, v130, 0
    v_pk_max_i16 v131, v131, 0
    s_add_u32 s39, s52, s56
    s_nop 0
    v_permlane16_swap_b32 v128, v130
    v_permlane16_swap_b32 v129, v131
    s_nop 1
    buffer_store_dwordx4 v[128:131], v245, s[20:23], s39 offen
    v_pk_fma_f32 v[32:33], v[152:153], v[112:113], v[32:33] op_sel_hi:[1,0,1] neg_lo:[0,1,0] neg_hi:[0,1,0]
    v_pk_fma_f32 v[34:35], v[154:155], v[112:113], v[34:35] op_sel_hi:[1,0,1] neg_lo:[0,1,0] neg_hi:[0,1,0]
    v_pk_mul_f32 v[32:33], v[32:33], v[112:113] op_sel:[0,1] op_sel_hi:[1,1]
    v_pk_mul_f32 v[34:35], v[34:35], v[112:113] op_sel:[0,1] op_sel_hi:[1,1]
    v_cvt_pk_bf16_f32 v132, v32, v33
    v_cvt_pk_bf16_f32 v133, v34, v35
    v_pk_max_i16 v132, v132, 0
    v_pk_max_i16 v133, v133, 0
    v_pk_fma_f32 v[48:49], v[156:157], v[112:113], v[48:49] op_sel_hi:[1,0,1] neg_lo:[0,1,0] neg_hi:[0,1,0]
    v_pk_fma_f32 v[50:51], v[158:159], v[112:113], v[50:51] op_sel_hi:[1,0,1] neg_lo:[0,1,0] neg_hi:[0,1,0]
    v_pk_mul_f32 v[48:49], v[48:49], v[112:113] op_sel:[0,1] op_sel_hi:[1,1]
    v_pk_mul_f32 v[50:51], v[50:51], v[112:113] op_sel:[0,1] op_sel_hi:[1,1]
    v_cvt_pk_bf16_f32 v134, v48, v49
    v_cvt_pk_bf16_f32 v135, v50, v51
    v_pk_max_i16 v134, v134, 0
    v_pk_max_i16 v135, v135, 0
    s_add_u32 s39, s52, s57
    s_nop 0
    v_permlane16_swap_b32 v132, v134
    v_permlane16_swap_b32 v133, v135
    s_nop 1
    buffer_store_dwordx4 v[132:135], v245, s[20:23], s39 offen
    v_pk_fma_f32 v[64:65], v[160:161], v[112:113], v[64:65] op_sel_hi:[1,0,1] neg_lo:[0,1,0] neg_hi:[0,1,0]
    v_pk_fma_f32 v[66:67], v[162:163], v[112:113], v[66:67] op_sel_hi:[1,0,1] neg_lo:[0,1,0] neg_hi:[0,1,0]
    v_pk_mul_f32 v[64:65], v[64:65], v[112:113] op_sel:[0,1] op_sel_hi:[1,1]
    v_pk_mul_f32 v[66:67], v[66:67], v[112:113] op_sel:[0,1] op_sel_hi:[1,1]
    v_cvt_pk_bf16_f32 v136, v64, v65
    v_cvt_pk_bf16_f32 v137, v66, v67
    v_pk_max_i16 v136, v136, 0
    v_pk_max_i16 v137, v137, 0
    v_pk_fma_f32 v[80:81], v[164:165], v[112:113], v[80:81] op_sel_hi:[1,0,1] neg_lo:[0,1,0] neg_hi:[0,1,0]
    v_pk_fma_f32 v[82:83], v[166:167], v[112:113], v[82:83] op_sel_hi:[1,0,1] neg_lo:[0,1,0] neg_hi:[0,1,0]
    v_pk_mul_f32 v[80:81], v[80:81], v[112:113] op_sel:[0,1] op_sel_hi:[1,1]
    v_pk_mul_f32 v[82:83], v[82:83], v[112:113] op_sel:[0,1] op_sel_hi:[1,1]
    v_cvt_pk_bf16_f32 v138, v80, v81
    v_cvt_pk_bf16_f32 v139, v82, v83
    v_pk_max_i16 v138, v138, 0
    v_pk_max_i16 v139, v139, 0
    s_add_u32 s39, s52, s58
    s_nop 0
    v_permlane16_swap_b32 v136, v138
    v_permlane16_swap_b32 v137, v139
    s_nop 1
    buffer_store_dwordx4 v[136:139], v245, s[20:23], s39 offen
    v_pk_fma_f32 v[96:97], v[168:169], v[112:113], v[96:97] op_sel_hi:[1,0,1] neg_lo:[0,1,0] neg_hi:[0,1,0]
    v_pk_fma_f32 v[98:99], v[170:171], v[112:113], v[98:99] op_sel_hi:[1,0,1] neg_lo:[0,1,0] neg_hi:[0,1,0]
    v_pk_mul_f32 v[96:97], v[96:97], v[112:113] op_sel:[0,1] op_sel_hi:[1,1]
    v_pk_mul_f32 v[98:99], v[98:99], v[112:113] op_sel:[0,1] op_sel_hi:[1,1]
    v_cvt_pk_bf16_f32 v140, v96, v97
    v_cvt_pk_bf16_f32 v141, v98, v99
    v_pk_max_i16 v140, v140, 0
    v_pk_max_i16 v141, v141, 0
    s_add_u32 s39, s52, s59
    s_nop 1
    buffer_store_dwordx2 v[140:141], v246, s[20:23], s39 offen
    v_pk_fma_f32 v[4:5], v[144:145], v[114:115], v[4:5] op_sel_hi:[1,0,1] neg_lo:[0,1,0] neg_hi:[0,1,0]
    v_pk_fma_f32 v[6:7], v[146:147], v[114:115], v[6:7] op_sel_hi:[1,0,1] neg_lo:[0,1,0] neg_hi:[0,1,0]
    v_pk_mul_f32 v[4:5], v[4:5], v[114:115] op_sel:[0,1] op_sel_hi:[1,1]
    v_pk_mul_f32 v[6:7], v[6:7], v[114:115] op_sel:[0,1] op_sel_hi:[1,1]
    v_cvt_pk_bf16_f32 v128, v4, v5
    v_cvt_pk_bf16_f32 v129, v6, v7
    v_pk_max_i16 v128, v128, 0
    v_pk_max_i16 v129, v129, 0
    v_pk_fma_f32 v[20:21], v[148:149], v[114:115], v[20:21] op_sel_hi:[1,0,1] neg_lo:[0,1,0] neg_hi:[0,1,0]
    v_pk_fma_f32 v[22:23], v[150:151], v[114:115], v[22:23] op_sel_hi:[1,0,1] neg_lo:[0,1,0] neg_hi:[0,1,0]
    v_pk_mul_f32 v[20:21], v[20:21], v[114:115] op_sel:[0,1] op_sel_hi:[1,1]
    v_pk_mul_f32 v[22:23], v[22:23], v[114:115] op_sel:[0,1] op_sel_hi:[1,1]
    v_cvt_pk_bf16_f32 v130, v20, v21
    v_cvt_pk_bf16_f32 v131, v22, v23
    v_pk_max_i16 v130, v130, 0
    v_pk_max_i16 v131, v131, 0
    s_add_u32 s39, s53, s56
    s_nop 0
    v_permlane16_swap_b32 v128, v130
    v_permlane16_swap_b32 v129, v131
    s_nop 1
    buffer_store_dwordx4 v[128:131], v245, s[20:23], s39 offen
    v_pk_fma_f32 v[36:37], v[152:153], v[114:115], v[36:37] op_sel_hi:[1,0,1] neg_lo:[0,1,0] neg_hi:[0,1,0]
    v_pk_fma_f32 v[38:39], v[154:155], v[114:115], v[38:39] op_sel_hi:[1,0,1] neg_lo:[0,1,0] neg_hi:[0,1,0]
    v_pk_mul_f32 v[36:37], v[36:37], v[114:115] op_sel:[0,1] op_sel_hi:[1,1]
    v_pk_mul_f32 v[38:39], v[38:39], v[114:115] op_sel:[0,1] op_sel_hi:[1,1]
    v_cvt_pk_bf16_f32 v132, v36, v37
    v_cvt_pk_bf16_f32 v133, v38, v39
    v_pk_max_i16 v132, v132, 0
    v_pk_max_i16 v133, v133, 0
    v_pk_fma_f32 v[52:53], v[156:157], v[114:115], v[52:53] op_sel_hi:[1,0,1] neg_lo:[0,1,0] neg_hi:[0,1,0]
    v_pk_fma_f32 v[54:55], v[158:159], v[114:115], v[54:55] op_sel_hi:[1,0,1] neg_lo:[0,1,0] neg_hi:[0,1,0]
    v_pk_mul_f32 v[52:53], v[52:53], v[114:115] op_sel:[0,1] op_sel_hi:[1,1]
    v_pk_mul_f32 v[54:55], v[54:55], v[114:115] op_sel:[0,1] op_sel_hi:[1,1]
    v_cvt_pk_bf16_f32 v134, v52, v53
    v_cvt_pk_bf16_f32 v135, v54, v55
    v_pk_max_i16 v134, v134, 0
    v_pk_max_i16 v135, v135, 0
    s_add_u32 s39, s53, s57
    s_nop 0
    v_permlane16_swap_b32 v132, v134
    v_permlane16_swap_b32 v133, v135
    s_nop 1
    buffer_store_dwordx4 v[132:135], v245, s[20:23], s39 offen
    v_pk_fma_f32 v[68:69], v[160:161], v[114:115], v[68:69] op_sel_hi:[1,0,1] neg_lo:[0,1,0] neg_hi:[0,1,0]
    v_pk_fma_f32 v[70:71], v[162:163], v[114:115], v[70:71] op_sel_hi:[1,0,1] neg_lo:[0,1,0] neg_hi:[0,1,0]
    v_pk_mul_f32 v[68:69], v[68:69], v[114:115] op_sel:[0,1] op_sel_hi:[1,1]
    v_pk_mul_f32 v[70:71], v[70:71], v[114:115] op_sel:[0,1] op_sel_hi:[1,1]
    v_cvt_pk_bf16_f32 v136, v68, v69
    v_cvt_pk_bf16_f32 v137, v70, v71
    v_pk_max_i16 v136, v136, 0
    v_pk_max_i16 v137, v137, 0
    v_pk_fma_f32 v[84:85], v[164:165], v[114:115], v[84:85] op_sel_hi:[1,0,1] neg_lo:[0,1,0] neg_hi:[0,1,0]
    v_pk_fma_f32 v[86:87], v[166:167], v[114:115], v[86:87] op_sel_hi:[1,0,1] neg_lo:[0,1,0] neg_hi:[0,1,0]
    v_pk_mul_f32 v[84:85], v[84:85], v[114:115] op_sel:[0,1] op_sel_hi:[1,1]
    v_pk_mul_f32 v[86:87], v[86:87], v[114:115] op_sel:[0,1] op_sel_hi:[1,1]
    v_cvt_pk_bf16_f32 v138, v84, v85
    v_cvt_pk_bf16_f32 v139, v86, v87
    v_pk_max_i16 v138, v138, 0
    v_pk_max_i16 v139, v139, 0
    s_add_u32 s39, s53, s58
    s_nop 0
    v_permlane16_swap_b32 v136, v138
    v_permlane16_swap_b32 v137, v139
    s_nop 1
    buffer_store_dwordx4 v[136:139], v245, s[20:23], s39 offen
    v_pk_fma_f32 v[100:101], v[168:169], v[114:115], v[100:101] op_sel_hi:[1,0,1] neg_lo:[0,1,0] neg_hi:[0,1,0]
    v_pk_fma_f32 v[102:103], v[170:171], v[114:115], v[102:103] op_sel_hi:[1,0,1] neg_lo:[0,1,0] neg_hi:[0,1,0]
    v_pk_mul_f32 v[100:101], v[100:101], v[114:115] op_sel:[0,1] op_sel_hi:[1,1]
    v_pk_mul_f32 v[102:103], v[102:103], v[114:115] op_sel:[0,1] op_sel_hi:[1,1]
    v_cvt_pk_bf16_f32 v140, v100, v101
    v_cvt_pk_bf16_f32 v141, v102, v103
    v_pk_max_i16 v140, v140, 0
    v_pk_max_i16 v141, v141, 0
    s_add_u32 s39, s53, s59
    s_nop 1
    buffer_store_dwordx2 v[140:141], v246, s[20:23], s39 offen
    v_pk_fma_f32 v[8:9], v[144:145], v[116:117], v[8:9] op_sel_hi:[1,0,1] neg_lo:[0,1,0] neg_hi:[0,1,0]
    v_pk_fma_f32 v[10:11], v[146:147], v[116:117], v[10:11] op_sel_hi:[1,0,1] neg_lo:[0,1,0] neg_hi:[0,1,0]
    v_pk_mul_f32 v[8:9], v[8:9], v[116:117] op_sel:[0,1] op_sel_hi:[1,1]
    v_pk_mul_f32 v[10:11], v[10:11], v[116:117] op_sel:[0,1] op_sel_hi:[1,1]
    v_cvt_pk_bf16_f32 v128, v8, v9
    v_cvt_pk_bf16_f32 v129, v10, v11
    v_pk_max_i16 v128, v128, 0
    v_pk_max_i16 v129, v129, 0
    v_pk_fma_f32 v[24:25], v[148:149], v[116:117], v[24:25] op_sel_hi:[1,0,1] neg_lo:[0,1,0] neg_hi:[0,1,0]
    v_pk_fma_f32 v[26:27], v[150:151], v[116:117], v[26:27] op_sel_hi:[1,0,1] neg_lo:[0,1,0] neg_hi:[0,1,0]
    v_pk_mul_f32 v[24:25], v[24:25], v[116:117] op_sel:[0,1] op_sel_hi:[1,1]
    v_pk_mul_f32 v[26:27], v[26:27], v[116:117] op_sel:[0,1] op_sel_hi:[1,1]
    v_cvt_pk_bf16_f32 v130, v24, v25
    v_cvt_pk_bf16_f32 v131, v26, v27
    v_pk_max_i16 v130, v130, 0
    v_pk_max_i16 v131, v131, 0
    s_add_u32 s39, s54, s56
    s_nop 0
    v_permlane16_swap_b32 v128, v130
    v_permlane16_swap_b32 v129, v131
    s_nop 1
    buffer_store_dwordx4 v[128:131], v245, s[20:23], s39 offen
    v_pk_fma_f32 v[40:41], v[152:153], v[116:117], v[40:41] op_sel_hi:[1,0,1] neg_lo:[0,1,0] neg_hi:[0,1,0]
    v_pk_fma_f32 v[42:43], v[154:155], v[116:117], v[42:43] op_sel_hi:[1,0,1] neg_lo:[0,1,0] neg_hi:[0,1,0]
    v_pk_mul_f32 v[40:41], v[40:41], v[116:117] op_sel:[0,1] op_sel_hi:[1,1]
    v_pk_mul_f32 v[42:43], v[42:43], v[116:117] op_sel:[0,1] op_sel_hi:[1,1]
    v_cvt_pk_bf16_f32 v132, v40, v41
    v_cvt_pk_bf16_f32 v133, v42, v43
    v_pk_max_i16 v132, v132, 0
    v_pk_max_i16 v133, v133, 0
    v_pk_fma_f32 v[56:57], v[156:157], v[116:117], v[56:57] op_sel_hi:[1,0,1] neg_lo:[0,1,0] neg_hi:[0,1,0]
    v_pk_fma_f32 v[58:59], v[158:159], v[116:117], v[58:59] op_sel_hi:[1,0,1] neg_lo:[0,1,0] neg_hi:[0,1,0]
    v_pk_mul_f32 v[56:57], v[56:57], v[116:117] op_sel:[0,1] op_sel_hi:[1,1]
    v_pk_mul_f32 v[58:59], v[58:59], v[116:117] op_sel:[0,1] op_sel_hi:[1,1]
    v_cvt_pk_bf16_f32 v134, v56, v57
    v_cvt_pk_bf16_f32 v135, v58, v59
    v_pk_max_i16 v134, v134, 0
    v_pk_max_i16 v135, v135, 0
    s_add_u32 s39, s54, s57
    s_nop 0
    v_permlane16_swap_b32 v132, v134
    v_permlane16_swap_b32 v133, v135
    s_nop 1
    buffer_store_dwordx4 v[132:135], v245, s[20:23], s39 offen
    v_pk_fma_f32 v[72:73], v[160:161], v[116:117], v[72:73] op_sel_hi:[1,0,1] neg_lo:[0,1,0] neg_hi:[0,1,0]
    v_pk_fma_f32 v[74:75], v[162:163], v[116:117], v[74:75] op_sel_hi:[1,0,1] neg_lo:[0,1,0] neg_hi:[0,1,0]
    v_pk_mul_f32 v[72:73], v[72:73], v[116:117] op_sel:[0,1] op_sel_hi:[1,1]
    v_pk_mul_f32 v[74:75], v[74:75], v[116:117] op_sel:[0,1] op_sel_hi:[1,1]
    v_cvt_pk_bf16_f32 v136, v72, v73
    v_cvt_pk_bf16_f32 v137, v74, v75
    v_pk_max_i16 v136, v136, 0
    v_pk_max_i16 v137, v137, 0
    v_pk_fma_f32 v[88:89], v[164:165], v[116:117], v[88:89] op_sel_hi:[1,0,1] neg_lo:[0,1,0] neg_hi:[0,1,0]
    v_pk_fma_f32 v[90:91], v[166:167], v[116:117], v[90:91] op_sel_hi:[1,0,1] neg_lo:[0,1,0] neg_hi:[0,1,0]
    v_pk_mul_f32 v[88:89], v[88:89], v[116:117] op_sel:[0,1] op_sel_hi:[1,1]
    v_pk_mul_f32 v[90:91], v[90:91], v[116:117] op_sel:[0,1] op_sel_hi:[1,1]
    v_cvt_pk_bf16_f32 v138, v88, v89
    v_cvt_pk_bf16_f32 v139, v90, v91
    v_pk_max_i16 v138, v138, 0
    v_pk_max_i16 v139, v139, 0
    s_add_u32 s39, s54, s58
    s_nop 0
    v_permlane16_swap_b32 v136, v138
    v_permlane16_swap_b32 v137, v139
    s_nop 1
    buffer_store_dwordx4 v[136:139], v245, s[20:23], s39 offen
    v_pk_fma_f32 v[104:105], v[168:169], v[116:117], v[104:105] op_sel_hi:[1,0,1] neg_lo:[0,1,0] neg_hi:[0,1,0]
    v_pk_fma_f32 v[106:107], v[170:171], v[116:117], v[106:107] op_sel_hi:[1,0,1] neg_lo:[0,1,0] neg_hi:[0,1,0]
    v_pk_mul_f32 v[104:105], v[104:105], v[116:117] op_sel:[0,1] op_sel_hi:[1,1]
    v_pk_mul_f32 v[106:107], v[106:107], v[116:117] op_sel:[0,1] op_sel_hi:[1,1]
    v_cvt_pk_bf16_f32 v140, v104, v105
    v_cvt_pk_bf16_f32 v141, v106, v107
    v_pk_max_i16 v140, v140, 0
    v_pk_max_i16 v141, v141, 0
    s_add_u32 s39, s54, s59
    s_nop 1
    buffer_store_dwordx2 v[140:141], v246, s[20:23], s39 offen
    v_pk_fma_f32 v[12:13], v[144:145], v[118:119], v[12:13] op_sel_hi:[1,0,1] neg_lo:[0,1,0] neg_hi:[0,1,0]
    v_pk_fma_f32 v[14:15], v[146:147], v[118:119], v[14:15] op_sel_hi:[1,0,1] neg_lo:[0,1,0] neg_hi:[0,1,0]
    v_pk_mul_f32 v[12:13], v[12:13], v[118:119] op_sel:[0,1] op_sel_hi:[1,1]
    v_pk_mul_f32 v[14:15], v[14:15], v[118:119] op_sel:[0,1] op_sel_hi:[1,1]
    v_cvt_pk_bf16_f32 v128, v12, v13
    v_cvt_pk_bf16_f32 v129, v14, v15
    v_pk_max_i16 v128, v128, 0
    v_pk_max_i16 v129, v129, 0
    v_pk_fma_f32 v[28:29], v[148:149], v[118:119], v[28:29] op_sel_hi:[1,0,1] neg_lo:[0,1,0] neg_hi:[0,1,0]
    v_pk_fma_f32 v[30:31], v[150:151], v[118:119], v[30:31] op_sel_hi:[1,0,1] neg_lo:[0,1,0] neg_hi:[0,1,0]
    v_pk_mul_f32 v[28:29], v[28:29], v[118:119] op_sel:[0,1] op_sel_hi:[1,1]
    v_pk_mul_f32 v[30:31], v[30:31], v[118:119] op_sel:[0,1] op_sel_hi:[1,1]
    v_cvt_pk_bf16_f32 v130, v28, v29
    v_cvt_pk_bf16_f32 v131, v30, v31
    v_pk_max_i16 v130, v130, 0
    v_pk_max_i16 v131, v131, 0
    s_add_u32 s39, s55, s56
    s_nop 0
    v_permlane16_swap_b32 v128, v130
    v_permlane16_swap_b32 v129, v131
    s_nop 1
    buffer_store_dwordx4 v[128:131], v245, s[20:23], s39 offen
    v_pk_fma_f32 v[44:45], v[152:153], v[118:119], v[44:45] op_sel_hi:[1,0,1] neg_lo:[0,1,0] neg_hi:[0,1,0]
    v_pk_fma_f32 v[46:47], v[154:155], v[118:119], v[46:47] op_sel_hi:[1,0,1] neg_lo:[0,1,0] neg_hi:[0,1,0]
    v_pk_mul_f32 v[44:45], v[44:45], v[118:119] op_sel:[0,1] op_sel_hi:[1,1]
    v_pk_mul_f32 v[46:47], v[46:47], v[118:119] op_sel:[0,1] op_sel_hi:[1,1]
    v_cvt_pk_bf16_f32 v132, v44, v45
    v_cvt_pk_bf16_f32 v133, v46, v47
    v_pk_max_i16 v132, v132, 0
    v_pk_max_i16 v133, v133, 0
    v_pk_fma_f32 v[60:61], v[156:157], v[118:119], v[60:61] op_sel_hi:[1,0,1] neg_lo:[0,1,0] neg_hi:[0,1,0]
    v_pk_fma_f32 v[62:63], v[158:159], v[118:119], v[62:63] op_sel_hi:[1,0,1] neg_lo:[0,1,0] neg_hi:[0,1,0]
    v_pk_mul_f32 v[60:61], v[60:61], v[118:119] op_sel:[0,1] op_sel_hi:[1,1]
    v_pk_mul_f32 v[62:63], v[62:63], v[118:119] op_sel:[0,1] op_sel_hi:[1,1]
    v_cvt_pk_bf16_f32 v134, v60, v61
    v_cvt_pk_bf16_f32 v135, v62, v63
    v_pk_max_i16 v134, v134, 0
    v_pk_max_i16 v135, v135, 0
    s_add_u32 s39, s55, s57
    s_nop 0
    v_permlane16_swap_b32 v132, v134
    v_permlane16_swap_b32 v133, v135
    s_nop 1
    buffer_store_dwordx4 v[132:135], v245, s[20:23], s39 offen
    v_pk_fma_f32 v[76:77], v[160:161], v[118:119], v[76:77] op_sel_hi:[1,0,1] neg_lo:[0,1,0] neg_hi:[0,1,0]
    v_pk_fma_f32 v[78:79], v[162:163], v[118:119], v[78:79] op_sel_hi:[1,0,1] neg_lo:[0,1,0] neg_hi:[0,1,0]
    v_pk_mul_f32 v[76:77], v[76:77], v[118:119] op_sel:[0,1] op_sel_hi:[1,1]
    v_pk_mul_f32 v[78:79], v[78:79], v[118:119] op_sel:[0,1] op_sel_hi:[1,1]
    v_cvt_pk_bf16_f32 v136, v76, v77
    v_cvt_pk_bf16_f32 v137, v78, v79
    v_pk_max_i16 v136, v136, 0
    v_pk_max_i16 v137, v137, 0
    v_pk_fma_f32 v[92:93], v[164:165], v[118:119], v[92:93] op_sel_hi:[1,0,1] neg_lo:[0,1,0] neg_hi:[0,1,0]
    v_pk_fma_f32 v[94:95], v[166:167], v[118:119], v[94:95] op_sel_hi:[1,0,1] neg_lo:[0,1,0] neg_hi:[0,1,0]
    v_pk_mul_f32 v[92:93], v[92:93], v[118:119] op_sel:[0,1] op_sel_hi:[1,1]
    v_pk_mul_f32 v[94:95], v[94:95], v[118:119] op_sel:[0,1] op_sel_hi:[1,1]
    v_cvt_pk_bf16_f32 v138, v92, v93
    v_cvt_pk_bf16_f32 v139, v94, v95
    v_pk_max_i16 v138, v138, 0
    v_pk_max_i16 v139, v139, 0
    s_add_u32 s39, s55, s58
    s_nop 0
    v_permlane16_swap_b32 v136, v138
    v_permlane16_swap_b32 v137, v139
    s_nop 1
    buffer_store_dwordx4 v[136:139], v245, s[20:23], s39 offen
    v_pk_fma_f32 v[108:109], v[168:169], v[118:119], v[108:109] op_sel_hi:[1,0,1] neg_lo:[0,1,0] neg_hi:[0,1,0]
    v_pk_fma_f32 v[110:111], v[170:171], v[118:119], v[110:111] op_sel_hi:[1,0,1] neg_lo:[0,1,0] neg_hi:[0,1,0]
    v_pk_mul_f32 v[108:109], v[108:109], v[118:119] op_sel:[0,1] op_sel_hi:[1,1]
    v_pk_mul_f32 v[110:111], v[110:111], v[118:119] op_sel:[0,1] op_sel_hi:[1,1]
    v_cvt_pk_bf16_f32 v140, v108, v109
    v_cvt_pk_bf16_f32 v141, v110, v111
    v_pk_max_i16 v140, v140, 0
    v_pk_max_i16 v141, v141, 0
    s_add_u32 s39, s55, s59
    s_nop 1
    buffer_store_dwordx2 v[140:141], v246, s[20:23], s39 offen
    s_endpgm
g1_attn:
    s_lshl_b32 s39, s24, 5
    v_lshlrev_b32 v236, 1, v251
    v_add_u32 v237, s39, v236
    v_add_u32 v238, 16, v237
    v_mul_u32_u24 v238, 400, v238
    v_lshl_add_u32 v0, v252, 4, v238
    v_add_u32 v2, 64, v0
    v_add_u32 v238, -16, v237
    v_max_i32 v238, 0, v238
    v_mul_u32_u24 v238, 400, v238
    v_lshl_add_u32 v238, v252, 4, v238
    v_add_u32 v1, 64, v238
    v_lshrrev_b32 v236, 2, v251
    v_lshl_add_u32 v236, v252, 2, v236
    v_lshlrev_b32 v236, 1, v236
    v_add_u32 v236, s39, v236
    v_and_b32 v239, 3, v250
    v_lshlrev_b32 v239, 3, v239
    v_add_u32 v239, 128, v239
    v_add_u32 v238, 16, v236
    v_mul_u32_u24 v238, 400, v238
    v_add_u32 v4, v238, v239
    v_add_u32 v238, -16, v236
    v_max_i32 v238, 0, v238
    v_mul_u32_u24 v238, 400, v238
    v_add_u32 v3, v238, v239
    v_lshlrev_b32 v236, 2, v252
    v_sub_u32 v5, v251, v236
    v_add_u32 v236, 16, v5
    v_cmp_ge_u32 s[64:65], 7, v236
    v_add_u32 v236, 15, v5
    v_cmp_ge_u32 s[66:67], 7, v236
    v_add_u32 v236, 14, v5
    v_cmp_ge_u32 s[68:69], 7, v236
    v_add_u32 v236, 13, v5
    v_cmp_ge_u32 s[70:71], 7, v236
    v_add_u32 v236, 0, v5
    v_cmp_ge_u32 s[72:73], 7, v236
    v_add_u32 v236, -1, v5
    v_cmp_ge_u32 s[74:75], 7, v236
    v_add_u32 v236, -2, v5
    v_cmp_ge_u32 s[76:77], 7, v236
    v_add_u32 v236, -3, v5
    v_cmp_ge_u32 s[78:79], 7, v236
    s_or_b32 s39, s29, s24
    s_cmp_eq_u32 s39, 0
    s_cbranch_scc0 g1_attn_m
    s_mov_b64 s[64:65], 0
    s_mov_b64 s[66:67], 0
    s_mov_b64 s[68:69], 0
    s_mov_b64 s[70:71], 0
g1_attn_m:
    v_and_b32 v236, 7, v251
    v_lshlrev_b32 v236, 1, v236
    v_lshl_add_u32 v236, v244, 4, v236
    v_lshlrev_b32 v236, 4, v236
    v_lshrrev_b32 v237, 3, v251
    s_mov_b32 s39, 147456
    v_mul_lo_u32 v237, v237, s39
    v_add_u32 v6, v236, v237
    s_lshl_b32 s39, s29, 4
    s_lshl_b32 s42, s24, 1
    s_add_u32 s39, s39, s42
    s_mul_i32 s39, s39, 147456
    s_lshl_b32 s42, s30, 11
    s_add_u32 s43, s39, s42
    v_mov_b32 v246, 0xff800000
    v_mov_b32 v240, 0x3e3504f3
    v_mov_b32 v241, 0x3e3504f3
    v_mov_b32 v242, 0x3fb8aa3b
    v_mov_b32 v243, 0x3fb8aa3b
    ds_read_b128 v[8:11], v0 offset:0
    ds_read_b128 v[12:15], v1 offset:0
    ds_read_b128 v[16:19], v2 offset:0
    ds_read_b64_tr_b16 v[20:21], v3 offset:0
    ds_read_b64_tr_b16 v[22:23], v4 offset:0
    ds_read_b64_tr_b16 v[24:25], v3 offset:32
    ds_read_b64_tr_b16 v[26:27], v4 offset:32
    ds_read_b128 v[40:43], v0 offset:400
    ds_read_b128 v[44:47], v1 offset:400
    ds_read_b128 v[48:51], v2 offset:400
    ds_read_b64_tr_b16 v[52:53], v3 offset:400
    ds_read_b64_tr_b16 v[54:55], v4 offset:400
    ds_read_b64_tr_b16 v[56:57], v3 offset:432
    ds_read_b64_tr_b16 v[58:59], v4 offset:432
    ds_read_b128 v[72:75], v0 offset:192
    ds_read_b128 v[76:79], v1 offset:192
    ds_read_b128 v[80:83], v2 offset:192
    ds_read_b64_tr_b16 v[84:85], v3 offset:192
    ds_read_b64_tr_b16 v[86:87], v4 offset:192
    ds_read_b64_tr_b16 v[88:89], v3 offset:224
    ds_read_b64_tr_b16 v[90:91], v4 offset:224
    ds_read_b128 v[104:107], v0 offset:592
    ds_read_b128 v[108:111], v1 offset:592
    ds_read_b128 v[112:115], v2 offset:592
    ds_read_b64_tr_b16 v[116:117], v3 offset:592
    ds_read_b64_tr_b16 v[118:119], v4 offset:592
    ds_read_b64_tr_b16 v[120:121], v3 offset:624
    ds_read_b64_tr_b16 v[122:123], v4 offset:624
    s_waitcnt lgkmcnt(0)
    v_mfma_f32_16x16x32_bf16 v[28:31], v[12:15], v[8:11], 0
    v_mfma_f32_16x16x32_bf16 v[32:35], v[16:19], v[8:11], 0
    v_mfma_f32_16x16x32_bf16 v[60:63], v[44:47], v[40:43], 0
    v_mfma_f32_16x16x32_bf16 v[64:67], v[48:51], v[40:43], 0
    v_mfma_f32_16x16x32_bf16 v[92:95], v[76:79], v[72:75], 0
    v_mfma_f32_16x16x32_bf16 v[96:99], v[80:83], v[72:75], 0
    v_mfma_f32_16x16x32_bf16 v[124:127], v[108:111], v[104:107], 0
    v_mfma_f32_16x16x32_bf16 v[128:131], v[112:115], v[104:107], 0
    s_nop 7
    v_cvt_pk_bf16_f32 v36, v28, v29
    v_lshlrev_b32 v28, 16, v36
    v_and_b32 v29, 0xffff0000, v36
    v_pk_mul_f32 v[28:29], v[28:29], v[240:241]
    v_cvt_pk_bf16_f32 v36, v28, v29
    v_lshlrev_b32 v28, 16, v36
    v_and_b32 v29, 0xffff0000, v36
    v_cndmask_b32 v28, v246, v28, s[64:65]
    v_cndmask_b32 v29, v246, v29, s[66:67]
    v_cvt_pk_bf16_f32 v36, v30, v31
    v_lshlrev_b32 v30, 16, v36
    v_and_b32 v31, 0xffff0000, v36
    v_pk_mul_f32 v[30:31], v[30:31], v[240:241]
    v_cvt_pk_bf16_f32 v36, v30, v31
    v_lshlrev_b32 v30, 16, v36
    v_and_b32 v31, 0xffff0000, v36
    v_cndmask_b32 v30, v246, v30, s[68:69]
    v_cndmask_b32 v31, v246, v31, s[70:71]
    v_cvt_pk_bf16_f32 v36, v32, v33
    v_lshlrev_b32 v32, 16, v36
    v_and_b32 v33, 0xffff0000, v36
    v_pk_mul_f32 v[32:33], v[32:33], v[240:241]
    v_cvt_pk_bf16_f32 v36, v32, v33
    v_lshlrev_b32 v32, 16, v36
    v_and_b32 v33, 0xffff0000, v36
    v_cndmask_b32 v32, v246, v32, s[72:73]
    v_cndmask_b32 v33, v246, v33, s[74:75]
    v_cvt_pk_bf16_f32 v36, v34, v35
    v_lshlrev_b32 v34, 16, v36
    v_and_b32 v35, 0xffff0000, v36
    v_pk_mul_f32 v[34:35], v[34:35], v[240:241]
    v_cvt_pk_bf16_f32 v36, v34, v35
    v_lshlrev_b32 v34, 16, v36
    v_and_b32 v35, 0xffff0000, v36
    v_cndmask_b32 v34, v246, v34, s[76:77]
    v_cndmask_b32 v35, v246, v35, s[78:79]
    v_max3_f32 v36, v28, v29, v30
    v_max3_f32 v36, v36, v31, v32
    v_max3_f32 v36, v36, v33, v34
    v_max_f32 v36, v36, v35
    v_mov_b32 v37, v36
    s_nop 1
    v_permlane16_swap_b32 v36, v37
    s_nop 1
    v_max_f32 v36, v36, v37
    v_mov_b32 v37, v36
    s_nop 1
    v_permlane32_swap_b32 v36, v37
    s_nop 1
    v_max_f32 v36, v36, v37
    v_pk_add_f32 v[28:29], v[28:29], v[36:37] op_sel_hi:[1,0] neg_lo:[0,1] neg_hi:[0,1]
    v_pk_mul_f32 v[28:29], v[28:29], v[242:243]
    v_pk_add_f32 v[30:31], v[30:31], v[36:37] op_sel_hi:[1,0] neg_lo:[0,1] neg_hi:[0,1]
    v_pk_mul_f32 v[30:31], v[30:31], v[242:243]
    v_pk_add_f32 v[32:33], v[32:33], v[36:37] op_sel_hi:[1,0] neg_lo:[0,1] neg_hi:[0,1]
    v_pk_mul_f32 v[32:33], v[32:33], v[242:243]
    v_pk_add_f32 v[34:35], v[34:35], v[36:37] op_sel_hi:[1,0] neg_lo:[0,1] neg_hi:[0,1]
    v_pk_mul_f32 v[34:35], v[34:35], v[242:243]
    v_exp_f32 v28, v28
    v_exp_f32 v29, v29
    v_exp_f32 v30, v30
    v_exp_f32 v31, v31
    v_exp_f32 v32, v32
    v_exp_f32 v33, v33
    v_exp_f32 v34, v34
    v_exp_f32 v35, v35
    s_nop 0
    v_pk_add_f32 v[36:37], v[28:29], v[30:31]
    v_pk_add_f32 v[38:39], v[32:33], v[34:35]
    v_pk_add_f32 v[36:37], v[36:37], v[38:39]
    v_add_f32 v36, v36, v37
    v_mov_b32 v37, v36
    s_nop 1
    v_permlane16_swap_b32 v36, v37
    s_nop 1
    v_add_f32 v36, v36, v37
    v_mov_b32 v37, v36
    s_nop 1
    v_permlane32_swap_b32 v36, v37
    s_nop 1
    v_add_f32 v36, v36, v37
    v_rcp_f32 v36, v36
    s_nop 0
    v_pk_mul_f32 v[28:29], v[28:29], v[36:37] op_sel_hi:[1,0]
    v_pk_mul_f32 v[30:31], v[30:31], v[36:37] op_sel_hi:[1,0]
    v_pk_mul_f32 v[32:33], v[32:33], v[36:37] op_sel_hi:[1,0]
    v_pk_mul_f32 v[34:35], v[34:35], v[36:37] op_sel_hi:[1,0]
    v_cvt_pk_bf16_f32 v8, v28, v29
    v_cvt_pk_bf16_f32 v9, v30, v31
    v_cvt_pk_bf16_f32 v10, v32, v33
    v_cvt_pk_bf16_f32 v11, v34, v35
    s_nop 1
    v_mfma_f32_16x16x32_bf16 v[12:15], v[20:23], v[8:11], 0
    v_mfma_f32_16x16x32_bf16 v[16:19], v[24:27], v[8:11], 0
    v_cvt_pk_bf16_f32 v68, v60, v61
    v_lshlrev_b32 v60, 16, v68
    v_and_b32 v61, 0xffff0000, v68
    v_pk_mul_f32 v[60:61], v[60:61], v[240:241]
    v_cvt_pk_bf16_f32 v68, v60, v61
    v_lshlrev_b32 v60, 16, v68
    v_and_b32 v61, 0xffff0000, v68
    v_cndmask_b32 v60, v246, v60, s[64:65]
    v_cndmask_b32 v61, v246, v61, s[66:67]
    v_cvt_pk_bf16_f32 v68, v62, v63
    v_lshlrev_b32 v62, 16, v68
    v_and_b32 v63, 0xffff0000, v68
    v_pk_mul_f32 v[62:63], v[62:63], v[240:241]
    v_cvt_pk_bf16_f32 v68, v62, v63
    v_lshlrev_b32 v62, 16, v68
    v_and_b32 v63, 0xffff0000, v68
    v_cndmask_b32 v62, v246, v62, s[68:69]
    v_cndmask_b32 v63, v246, v63, s[70:71]
    v_cvt_pk_bf16_f32 v68, v64, v65
    v_lshlrev_b32 v64, 16, v68
    v_and_b32 v65, 0xffff0000, v68
    v_pk_mul_f32 v[64:65], v[64:65], v[240:241]
    v_cvt_pk_bf16_f32 v68, v64, v65
    v_lshlrev_b32 v64, 16, v68
    v_and_b32 v65, 0xffff0000, v68
    v_cndmask_b32 v64, v246, v64, s[72:73]
    v_cndmask_b32 v65, v246, v65, s[74:75]
    v_cvt_pk_bf16_f32 v68, v66, v67
    v_lshlrev_b32 v66, 16, v68
    v_and_b32 v67, 0xffff0000, v68
    v_pk_mul_f32 v[66:67], v[66:67], v[240:241]
    v_cvt_pk_bf16_f32 v68, v66, v67
    v_lshlrev_b32 v66, 16, v68
    v_and_b32 v67, 0xffff0000, v68
    v_cndmask_b32 v66, v246, v66, s[76:77]
    v_cndmask_b32 v67, v246, v67, s[78:79]
    v_max3_f32 v68, v60, v61, v62
    v_max3_f32 v68, v68, v63, v64
    v_max3_f32 v68, v68, v65, v66
    v_max_f32 v68, v68, v67
    v_mov_b32 v69, v68
    s_nop 1
    v_permlane16_swap_b32 v68, v69
    s_nop 1
    v_max_f32 v68, v68, v69
    v_mov_b32 v69, v68
    s_nop 1
    v_permlane32_swap_b32 v68, v69
    s_nop 1
    v_max_f32 v68, v68, v69
    v_pk_add_f32 v[60:61], v[60:61], v[68:69] op_sel_hi:[1,0] neg_lo:[0,1] neg_hi:[0,1]
    v_pk_mul_f32 v[60:61], v[60:61], v[242:243]
    v_pk_add_f32 v[62:63], v[62:63], v[68:69] op_sel_hi:[1,0] neg_lo:[0,1] neg_hi:[0,1]
    v_pk_mul_f32 v[62:63], v[62:63], v[242:243]
    v_pk_add_f32 v[64:65], v[64:65], v[68:69] op_sel_hi:[1,0] neg_lo:[0,1] neg_hi:[0,1]
    v_pk_mul_f32 v[64:65], v[64:65], v[242:243]
    v_pk_add_f32 v[66:67], v[66:67], v[68:69] op_sel_hi:[1,0] neg_lo:[0,1] neg_hi:[0,1]
    v_pk_mul_f32 v[66:67], v[66:67], v[242:243]
    v_exp_f32 v60, v60
    v_exp_f32 v61, v61
    v_exp_f32 v62, v62
    v_exp_f32 v63, v63
    v_exp_f32 v64, v64
    v_exp_f32 v65, v65
    v_exp_f32 v66, v66
    v_exp_f32 v67, v67
    s_nop 0
    v_pk_add_f32 v[68:69], v[60:61], v[62:63]
    v_pk_add_f32 v[70:71], v[64:65], v[66:67]
    v_pk_add_f32 v[68:69], v[68:69], v[70:71]
    v_add_f32 v68, v68, v69
    v_mov_b32 v69, v68
    s_nop 1
    v_permlane16_swap_b32 v68, v69
    s_nop 1
    v_add_f32 v68, v68, v69
    v_mov_b32 v69, v68
    s_nop 1
    v_permlane32_swap_b32 v68, v69
    s_nop 1
    v_add_f32 v68, v68, v69
    v_rcp_f32 v68, v68
    s_nop 0
    v_pk_mul_f32 v[60:61], v[60:61], v[68:69] op_sel_hi:[1,0]
    v_pk_mul_f32 v[62:63], v[62:63], v[68:69] op_sel_hi:[1,0]
    v_pk_mul_f32 v[64:65], v[64:65], v[68:69] op_sel_hi:[1,0]
    v_pk_mul_f32 v[66:67], v[66:67], v[68:69] op_sel_hi:[1,0]
    v_cvt_pk_bf16_f32 v40, v60, v61
    v_cvt_pk_bf16_f32 v41, v62, v63
    v_cvt_pk_bf16_f32 v42, v64, v65
    v_cvt_pk_bf16_f32 v43, v66, v67
    s_nop 1
    v_mfma_f32_16x16x32_bf16 v[44:47], v[52:55], v[40:43], 0
    v_mfma_f32_16x16x32_bf16 v[48:51], v[56:59], v[40:43], 0
    v_cvt_pk_bf16_f32 v100, v92, v93
    v_lshlrev_b32 v92, 16, v100
    v_and_b32 v93, 0xffff0000, v100
    v_pk_mul_f32 v[92:93], v[92:93], v[240:241]
    v_cvt_pk_bf16_f32 v100, v92, v93
    v_lshlrev_b32 v92, 16, v100
    v_and_b32 v93, 0xffff0000, v100
    v_cndmask_b32 v92, v246, v92, s[64:65]
    v_cndmask_b32 v93, v246, v93, s[66:67]
    v_cvt_pk_bf16_f32 v100, v94, v95
    v_lshlrev_b32 v94, 16, v100
    v_and_b32 v95, 0xffff0000, v100
    v_pk_mul_f32 v[94:95], v[94:95], v[240:241]
    v_cvt_pk_bf16_f32 v100, v94, v95
    v_lshlrev_b32 v94, 16, v100
    v_and_b32 v95, 0xffff0000, v100
    v_cndmask_b32 v94, v246, v94, s[68:69]
    v_cndmask_b32 v95, v246, v95, s[70:71]
    v_cvt_pk_bf16_f32 v100, v96, v97
    v_lshlrev_b32 v96, 16, v100
    v_and_b32 v97, 0xffff0000, v100
    v_pk_mul_f32 v[96:97], v[96:97], v[240:241]
    v_cvt_pk_bf16_f32 v100, v96, v97
    v_lshlrev_b32 v96, 16, v100
    v_and_b32 v97, 0xffff0000, v100
    v_cndmask_b32 v96, v246, v96, s[72:73]
    v_cndmask_b32 v97, v246, v97, s[74:75]
    v_cvt_pk_bf16_f32 v100, v98, v99
    v_lshlrev_b32 v98, 16, v100
    v_and_b32 v99, 0xffff0000, v100
    v_pk_mul_f32 v[98:99], v[98:99], v[240:241]
    v_cvt_pk_bf16_f32 v100, v98, v99
    v_lshlrev_b32 v98, 16, v100
    v_and_b32 v99, 0xffff0000, v100
    v_cndmask_b32 v98, v246, v98, s[76:77]
    v_cndmask_b32 v99, v246, v99, s[78:79]
    v_max3_f32 v100, v92, v93, v94
    v_max3_f32 v100, v100, v95, v96
    v_max3_f32 v100, v100, v97, v98
    v_max_f32 v100, v100, v99
    v_mov_b32 v101, v100
    s_nop 1
    v_permlane16_swap_b32 v100, v101
    s_nop 1
    v_max_f32 v100, v100, v101
    v_mov_b32 v101, v100
    s_nop 1
    v_permlane32_swap_b32 v100, v101
    s_nop 1
    v_max_f32 v100, v100, v101
    v_pk_add_f32 v[92:93], v[92:93], v[100:101] op_sel_hi:[1,0] neg_lo:[0,1] neg_hi:[0,1]
    v_pk_mul_f32 v[92:93], v[92:93], v[242:243]
    v_pk_add_f32 v[94:95], v[94:95], v[100:101] op_sel_hi:[1,0] neg_lo:[0,1] neg_hi:[0,1]
    v_pk_mul_f32 v[94:95], v[94:95], v[242:243]
    v_pk_add_f32 v[96:97], v[96:97], v[100:101] op_sel_hi:[1,0] neg_lo:[0,1] neg_hi:[0,1]
    v_pk_mul_f32 v[96:97], v[96:97], v[242:243]
    v_pk_add_f32 v[98:99], v[98:99], v[100:101] op_sel_hi:[1,0] neg_lo:[0,1] neg_hi:[0,1]
    v_pk_mul_f32 v[98:99], v[98:99], v[242:243]
    v_exp_f32 v92, v92
    v_exp_f32 v93, v93
    v_exp_f32 v94, v94
    v_exp_f32 v95, v95
    v_exp_f32 v96, v96
    v_exp_f32 v97, v97
    v_exp_f32 v98, v98
    v_exp_f32 v99, v99
    s_nop 0
    v_pk_add_f32 v[100:101], v[92:93], v[94:95]
    v_pk_add_f32 v[102:103], v[96:97], v[98:99]
    v_pk_add_f32 v[100:101], v[100:101], v[102:103]
    v_add_f32 v100, v100, v101
    v_mov_b32 v101, v100
    s_nop 1
    v_permlane16_swap_b32 v100, v101
    s_nop 1
    v_add_f32 v100, v100, v101
    v_mov_b32 v101, v100
    s_nop 1
    v_permlane32_swap_b32 v100, v101
    s_nop 1
    v_add_f32 v100, v100, v101
    v_rcp_f32 v100, v100
    s_nop 0
    v_pk_mul_f32 v[92:93], v[92:93], v[100:101] op_sel_hi:[1,0]
    v_pk_mul_f32 v[94:95], v[94:95], v[100:101] op_sel_hi:[1,0]
    v_pk_mul_f32 v[96:97], v[96:97], v[100:101] op_sel_hi:[1,0]
    v_pk_mul_f32 v[98:99], v[98:99], v[100:101] op_sel_hi:[1,0]
    v_cvt_pk_bf16_f32 v72, v92, v93
    v_cvt_pk_bf16_f32 v73, v94, v95
    v_cvt_pk_bf16_f32 v74, v96, v97
    v_cvt_pk_bf16_f32 v75, v98, v99
    s_nop 1
    v_mfma_f32_16x16x32_bf16 v[76:79], v[84:87], v[72:75], 0
    v_mfma_f32_16x16x32_bf16 v[80:83], v[88:91], v[72:75], 0
    v_cvt_pk_bf16_f32 v132, v124, v125
    v_lshlrev_b32 v124, 16, v132
    v_and_b32 v125, 0xffff0000, v132
    v_pk_mul_f32 v[124:125], v[124:125], v[240:241]
    v_cvt_pk_bf16_f32 v132, v124, v125
    v_lshlrev_b32 v124, 16, v132
    v_and_b32 v125, 0xffff0000, v132
    v_cndmask_b32 v124, v246, v124, s[64:65]
    v_cndmask_b32 v125, v246, v125, s[66:67]
    v_cvt_pk_bf16_f32 v132, v126, v127
    v_lshlrev_b32 v126, 16, v132
    v_and_b32 v127, 0xffff0000, v132
    v_pk_mul_f32 v[126:127], v[126:127], v[240:241]
    v_cvt_pk_bf16_f32 v132, v126, v127
    v_lshlrev_b32 v126, 16, v132
    v_and_b32 v127, 0xffff0000, v132
    v_cndmask_b32 v126, v246, v126, s[68:69]
    v_cndmask_b32 v127, v246, v127, s[70:71]
    v_cvt_pk_bf16_f32 v132, v128, v129
    v_lshlrev_b32 v128, 16, v132
    v_and_b32 v129, 0xffff0000, v132
    v_pk_mul_f32 v[128:129], v[128:129], v[240:241]
    v_cvt_pk_bf16_f32 v132, v128, v129
    v_lshlrev_b32 v128, 16, v132
    v_and_b32 v129, 0xffff0000, v132
    v_cndmask_b32 v128, v246, v128, s[72:73]
    v_cndmask_b32 v129, v246, v129, s[74:75]
    v_cvt_pk_bf16_f32 v132, v130, v131
    v_lshlrev_b32 v130, 16, v132
    v_and_b32 v131, 0xffff0000, v132
    v_pk_mul_f32 v[130:131], v[130:131], v[240:241]
    v_cvt_pk_bf16_f32 v132, v130, v131
    v_lshlrev_b32 v130, 16, v132
    v_and_b32 v131, 0xffff0000, v132
    v_cndmask_b32 v130, v246, v130, s[76:77]
    v_cndmask_b32 v131, v246, v131, s[78:79]
    v_max3_f32 v132, v124, v125, v126
    v_max3_f32 v132, v132, v127, v128
    v_max3_f32 v132, v132, v129, v130
    v_max_f32 v132, v132, v131
    v_mov_b32 v133, v132
    s_nop 1
    v_permlane16_swap_b32 v132, v133
    s_nop 1
    v_max_f32 v132, v132, v133
    v_mov_b32 v133, v132
    s_nop 1
    v_permlane32_swap_b32 v132, v133
    s_nop 1
    v_max_f32 v132, v132, v133
    v_pk_add_f32 v[124:125], v[124:125], v[132:133] op_sel_hi:[1,0] neg_lo:[0,1] neg_hi:[0,1]
    v_pk_mul_f32 v[124:125], v[124:125], v[242:243]
    v_pk_add_f32 v[126:127], v[126:127], v[132:133] op_sel_hi:[1,0] neg_lo:[0,1] neg_hi:[0,1]
    v_pk_mul_f32 v[126:127], v[126:127], v[242:243]
    v_pk_add_f32 v[128:129], v[128:129], v[132:133] op_sel_hi:[1,0] neg_lo:[0,1] neg_hi:[0,1]
    v_pk_mul_f32 v[128:129], v[128:129], v[242:243]
    v_pk_add_f32 v[130:131], v[130:131], v[132:133] op_sel_hi:[1,0] neg_lo:[0,1] neg_hi:[0,1]
    v_pk_mul_f32 v[130:131], v[130:131], v[242:243]
    v_exp_f32 v124, v124
    v_exp_f32 v125, v125
    v_exp_f32 v126, v126
    v_exp_f32 v127, v127
    v_exp_f32 v128, v128
    v_exp_f32 v129, v129
    v_exp_f32 v130, v130
    v_exp_f32 v131, v131
    s_nop 0
    v_pk_add_f32 v[132:133], v[124:125], v[126:127]
    v_pk_add_f32 v[134:135], v[128:129], v[130:131]
    v_pk_add_f32 v[132:133], v[132:133], v[134:135]
    v_add_f32 v132, v132, v133
    v_mov_b32 v133, v132
    s_nop 1
    v_permlane16_swap_b32 v132, v133
    s_nop 1
    v_add_f32 v132, v132, v133
    v_mov_b32 v133, v132
    s_nop 1
    v_permlane32_swap_b32 v132, v133
    s_nop 1
    v_add_f32 v132, v132, v133
    v_rcp_f32 v132, v132
    s_nop 0
    v_pk_mul_f32 v[124:125], v[124:125], v[132:133] op_sel_hi:[1,0]
    v_pk_mul_f32 v[126:127], v[126:127], v[132:133] op_sel_hi:[1,0]
    v_pk_mul_f32 v[128:129], v[128:129], v[132:133] op_sel_hi:[1,0]
    v_pk_mul_f32 v[130:131], v[130:131], v[132:133] op_sel_hi:[1,0]
    v_cvt_pk_bf16_f32 v104, v124, v125
    v_cvt_pk_bf16_f32 v105, v126, v127
    v_cvt_pk_bf16_f32 v106, v128, v129
    v_cvt_pk_bf16_f32 v107, v130, v131
    s_nop 1
    v_mfma_f32_16x16x32_bf16 v[108:111], v[116:119], v[104:107], 0
    v_mfma_f32_16x16x32_bf16 v[112:115], v[120:123], v[104:107], 0
    s_nop 7
    v_cvt_pk_bf16_f32 v28, v12, v13
    v_cvt_pk_bf16_f32 v29, v14, v15
    v_cvt_pk_bf16_f32 v30, v16, v17
    v_cvt_pk_bf16_f32 v31, v18, v19
    s_nop 1
    v_permlane16_swap_b32 v28, v30
    v_permlane16_swap_b32 v29, v31
    s_nop 1
    buffer_store_dwordx4 v[28:31], v6, s[20:23], s43 offen offset:0
    v_cvt_pk_bf16_f32 v60, v44, v45
    v_cvt_pk_bf16_f32 v61, v46, v47
    v_cvt_pk_bf16_f32 v62, v48, v49
    v_cvt_pk_bf16_f32 v63, v50, v51
    s_nop 1
    v_permlane16_swap_b32 v60, v62
    v_permlane16_swap_b32 v61, v63
    s_nop 1
    buffer_store_dwordx4 v[60:63], v6, s[20:23], s43 offen offset:16
    v_cvt_pk_bf16_f32 v92, v76, v77
    v_cvt_pk_bf16_f32 v93, v78, v79
    v_cvt_pk_bf16_f32 v94, v80, v81
    v_cvt_pk_bf16_f32 v95, v82, v83
    s_nop 1
    v_permlane16_swap_b32 v92, v94
    v_permlane16_swap_b32 v93, v95
    s_nop 1
    buffer_store_dwordx4 v[92:95], v6, s[20:23], s43 offen offset:1024
    v_cvt_pk_bf16_f32 v124, v108, v109
    v_cvt_pk_bf16_f32 v125, v110, v111
    v_cvt_pk_bf16_f32 v126, v112, v113
    v_cvt_pk_bf16_f32 v127, v114, v115
    s_nop 1
    v_permlane16_swap_b32 v124, v126
    v_permlane16_swap_b32 v125, v127
    s_nop 1
    buffer_store_dwordx4 v[124:127], v6, s[20:23], s43 offen offset:1040
    s_endpgm
g1_end:
    s_endpgm

.globl g2_kernel
.p2align 8
.type g2_kernel,@function
g2_kernel:
    s_cmp_ge_u32 s2, 256
    s_cbranch_scc1 g2_exit
    s_load_dwordx2 s[4:5], s[0:1], 0
    s_load_dwordx2 s[6:7], s[0:1], 16
    s_load_dwordx4 s[8:11], s[0:1], 40
    s_load_dwordx4 s[28:31], s[0:1], 56
    v_and_b32 v135, 63, v0
    v_lshrrev_b32 v138, 6, v0
    v_and_b32 v136, 15, v0
    v_readfirstlane_b32 s40, v138
    v_bfe_u32 v137, v0, 4, 2
    s_nop 2
    s_cmp_lg_u32 s40, 7
    s_cbranch_scc1 g2_nopf
    s_getpc_b64 s[70:71]
g2_kernel_pc:
    s_add_u32 s70, s70, g2_kernel-g2_kernel_pc
    s_addc_u32 s71, s71, -1
    v_lshlrev_b32 v138, 7, v135
    v_min_u32 v139, g2_exit-g2_kernel-4, v138
    global_load_dword v152, v139, s[70:71]
g2_nopf:
    s_and_b32 s46, s2, 3
    s_bfe_u32 s59, s2, 0x10002
    s_lshr_b32 s60, s2, 3
    s_and_b32 s44, s60, 3
    s_lshl_b32 s59, s59, 2
    s_add_u32 s44, s44, s59
    s_lshr_b32 s45, s60, 2
    s_lshl_b32 s66, s44, 3
    s_add_u32 s66, s66, s45
    s_lshr_b32 s67, s40, 2
    s_and_b32 s43, s40, 3
    s_and_b32 s42, s40, 1
    s_bfe_u32 s41, s40, 0x10001
    s_lshr_b32 s74, s40, 1
    s_xor_b32 s59, s67, 1
    s_lshl_b32 s60, s59, 3
    s_lshl_b32 s61, s44, 4
    s_add_u32 s60, s60, s61
    s_lshl_b32 s61, s43, 1
    s_add_u32 s60, s60, s61
    s_mul_i32 s60, s60, 147456
    v_lshl_add_u32 v133, v135, 4, s60
    s_mul_i32 s72, s59, 49152
    s_lshl_b32 s61, s43, 12
    s_add_u32 s72, s72, s61
    v_lshrrev_b32 v138, 4, v135
    s_lshl_b32 s59, s40, 3
    v_add_u32 v139, s59, v138
    v_lshlrev_b32 v139, 11, v139
    s_lshl_b32 s59, s45, 8
    v_add_u32 v139, s59, v139
    v_and_b32 v140, 1, v135
    v_lshl_add_u32 v139, v140, 4, v139
    v_bfe_u32 v140, v135, 1, 3
    s_lshl_b32 s59, s42, 2
    v_or_b32 v138, s59, v138
    v_xor_b32 v140, v140, v138
    v_lshl_add_u32 v134, v140, 5, v139
    s_lshl_b32 s73, s40, 11
    s_add_u32 s73, s73, 98304
    s_waitcnt lgkmcnt(0)
    s_mov_b32 s12, s30
    s_and_b32 s13, s31, 0xffff
    s_mov_b32 s15, 0x20000
    s_mov_b32 s19, 0x20000
    s_and_b32 s7, s7, 0xffff
    s_and_b32 s9, s9, 0xffff
    s_mov_b32 s63, 7340032
    s_mov_b32 s75, 18874368
    s_mov_b32 s64, s46
    s_lshl_b32 s65, s46, 3
    s_lshl_b32 s65, 1, s65
    s_mov_b32 s69, 0
    s_mov_b32 s78, 0
    s_add_u32 s20, s30, 67108864
    s_addc_u32 s21, s31, 0
    s_and_b32 s21, s21, 0xffff
    s_mov_b32 s22, 33554432
    s_mov_b32 s23, 0x20000
    s_add_u32 s36, s30, 31457280
    s_addc_u32 s37, s31, 0
    s_and_b32 s37, s37, 0xffff
    s_mov_b32 s38, 8192
    s_mov_b32 s39, 0x20000
    s_lshl_b32 s77, s66, 7
    s_lshl_b32 s59, s66, 2
    s_add_u32 s59, s59, s46
    s_lshl_b32 s59, s59, 3
    s_add_u32 s59, s59, s40
    s_lshl_b32 s78, s59, 13
    v_lshlrev_b32 v155, 4, v135
    s_mov_b32 s24, s4
    s_and_b32 s25, s5, 0xffff
    s_mov_b32 s26, 4194304
    s_mov_b32 s27, 0x20000
    s_mov_b32 s32, s10
    s_and_b32 s33, s11, 0xffff
    s_mov_b32 s34, 4194304
    s_mov_b32 s35, 0x20000
g2_gemm:
    s_mov_b32 s49, 0
    s_mov_b32 s50, 0
    s_mov_b32 s55, 0
    s_mov_b32 s56, 0
    s_mov_b32 s51, s72
    s_mov_b32 s52, s73
    s_mul_i32 s59, s64, 18
    s_add_u32 s59, s59, s49
    s_lshl_b32 s48, s59, 11
    s_cmp_ge_u32 s49, 18
    s_cselect_b32 s14, 0, s75
    s_cselect_b32 s53, 163840, s51
    s_mul_i32 s59, s64, 18
    s_add_u32 s59, s59, s50
    s_cmp_lt_u32 s59, 16
    s_cselect_b32 s16, s6, s8
    s_cselect_b32 s17, s7, s9
    s_cselect_b32 s18, 2097152, s63
    s_cselect_b32 s60, 0, 16
    s_sub_u32 s59, s59, s60
    s_lshl_b32 s62, s59, 17
    s_cmp_ge_u32 s50, 18
    s_cselect_b32 s18, 0, s18
    s_cselect_b32 s54, 163840, s52
    s_cmp_eq_u32 s67, 0
    s_cbranch_scc0 g2_pro1
    s_add_u32 m0, s54, 0
    s_add_u32 s61, s62, 0
    buffer_load_dwordx4 v134, s[16:19], s61 offen lds
    s_add_u32 m0, s54, 1024
    s_add_u32 s61, s62, 8192
    buffer_load_dwordx4 v134, s[16:19], s61 offen lds
    s_add_u32 s50, s50, 1
    s_add_u32 s56, s56, 1
    s_add_u32 s52, s52, 16384
    s_cmp_eq_u32 s56, 4
    s_cselect_b32 s56, 0, s56
    s_cselect_b32 s52, s73, s52
    s_mul_i32 s59, s64, 18
    s_add_u32 s59, s59, s50
    s_cmp_lt_u32 s59, 16
    s_cselect_b32 s16, s6, s8
    s_cselect_b32 s17, s7, s9
    s_cselect_b32 s18, 2097152, s63
    s_cselect_b32 s60, 0, 16
    s_sub_u32 s59, s59, s60
    s_lshl_b32 s62, s59, 17
    s_cmp_ge_u32 s50, 18
    s_cselect_b32 s18, 0, s18
    s_cselect_b32 s54, 163840, s52
    s_add_u32 m0, s53, 0
    s_add_u32 s61, s48, 0
    buffer_load_dwordx4 v133, s[12:15], s61 offen lds
    buffer_load_dwordx4 v133, s[12:15], s61 offen offset:1024 lds
    s_add_u32 m0, s53, 2048
    s_add_u32 s61, s48, 147456
    buffer_load_dwordx4 v133, s[12:15], s61 offen lds
    buffer_load_dwordx4 v133, s[12:15], s61 offen offset:1024 lds
    s_add_u32 s49, s49, 1
    s_add_u32 s55, s55, 1
    s_add_u32 s51, s51, 16384
    s_cmp_eq_u32 s55, 3
    s_cselect_b32 s55, 0, s55
    s_cselect_b32 s51, s72, s51
    s_mul_i32 s59, s64, 18
    s_add_u32 s59, s59, s49
    s_lshl_b32 s48, s59, 11
    s_cmp_ge_u32 s49, 18
    s_cselect_b32 s14, 0, s75
    s_cselect_b32 s53, 163840, s51
    s_add_u32 m0, s54, 0
    s_add_u32 s61, s62, 0
    buffer_load_dwordx4 v134, s[16:19], s61 offen lds
    s_add_u32 m0, s54, 1024
    s_add_u32 s61, s62, 8192
    buffer_load_dwordx4 v134, s[16:19], s61 offen lds
    s_add_u32 s50, s50, 1
    s_add_u32 s56, s56, 1
    s_add_u32 s52, s52, 16384
    s_cmp_eq_u32 s56, 4
    s_cselect_b32 s56, 0, s56
    s_cselect_b32 s52, s73, s52
    s_mul_i32 s59, s64, 18
    s_add_u32 s59, s59, s50
    s_cmp_lt_u32 s59, 16
    s_cselect_b32 s16, s6, s8
    s_cselect_b32 s17, s7, s9
    s_cselect_b32 s18, 2097152, s63
    s_cselect_b32 s60, 0, 16
    s_sub_u32 s59, s59, s60
    s_lshl_b32 s62, s59, 17
    s_cmp_ge_u32 s50, 18
    s_cselect_b32 s18, 0, s18
    s_cselect_b32 s54, 163840, s52
    s_add_u32 m0, s53, 0
    s_add_u32 s61, s48, 0
    buffer_load_dwordx4 v133, s[12:15], s61 offen lds
    buffer_load_dwordx4 v133, s[12:15], s61 offen offset:1024 lds
    s_add_u32 m0, s53, 2048
    s_add_u32 s61, s48, 147456
    buffer_load_dwordx4 v133, s[12:15], s61 offen lds
    buffer_load_dwordx4 v133, s[12:15], s61 offen offset:1024 lds
    s_add_u32 s49, s49, 1
    s_add_u32 s55, s55, 1
    s_add_u32 s51, s51, 16384
    s_cmp_eq_u32 s55, 3
    s_cselect_b32 s55, 0, s55
    s_cselect_b32 s51, s72, s51
    s_mul_i32 s59, s64, 18
    s_add_u32 s59, s59, s49
    s_lshl_b32 s48, s59, 11
    s_cmp_ge_u32 s49, 18
    s_cselect_b32 s14, 0, s75
    s_cselect_b32 s53, 163840, s51
    s_add_u32 m0, s54, 0
    s_add_u32 s61, s62, 0
    buffer_load_dwordx4 v134, s[16:19], s61 offen lds
    s_add_u32 m0, s54, 1024
    s_add_u32 s61, s62, 8192
    buffer_load_dwordx4 v134, s[16:19], s61 offen lds
    s_add_u32 s50, s50, 1
    s_add_u32 s56, s56, 1
    s_add_u32 s52, s52, 16384
    s_cmp_eq_u32 s56, 4
    s_cselect_b32 s56, 0, s56
    s_cselect_b32 s52, s73, s52
    s_mul_i32 s59, s64, 18
    s_add_u32 s59, s59, s50
    s_cmp_lt_u32 s59, 16
    s_cselect_b32 s16, s6, s8
    s_cselect_b32 s17, s7, s9
    s_cselect_b32 s18, 2097152, s63
    s_cselect_b32 s60, 0, 16
    s_sub_u32 s59, s59, s60
    s_lshl_b32 s62, s59, 17
    s_cmp_ge_u32 s50, 18
    s_cselect_b32 s18, 0, s18
    s_cselect_b32 s54, 163840, s52
    s_branch g2_pro2
g2_pro1:
    s_add_u32 m0, s53, 0
    s_add_u32 s61, s48, 0
    buffer_load_dwordx4 v133, s[12:15], s61 offen lds
    buffer_load_dwordx4 v133, s[12:15], s61 offen offset:1024 lds
    s_add_u32 m0, s53, 2048
    s_add_u32 s61, s48, 147456
    buffer_load_dwordx4 v133, s[12:15], s61 offen lds
    buffer_load_dwordx4 v133, s[12:15], s61 offen offset:1024 lds
    s_add_u32 s49, s49, 1
    s_add_u32 s55, s55, 1
    s_add_u32 s51, s51, 16384
    s_cmp_eq_u32 s55, 3
    s_cselect_b32 s55, 0, s55
    s_cselect_b32 s51, s72, s51
    s_mul_i32 s59, s64, 18
    s_add_u32 s59, s59, s49
    s_lshl_b32 s48, s59, 11
    s_cmp_ge_u32 s49, 18
    s_cselect_b32 s14, 0, s75
    s_cselect_b32 s53, 163840, s51
    s_add_u32 m0, s54, 0
    s_add_u32 s61, s62, 0
    buffer_load_dwordx4 v134, s[16:19], s61 offen lds
    s_add_u32 m0, s54, 1024
    s_add_u32 s61, s62, 8192
    buffer_load_dwordx4 v134, s[16:19], s61 offen lds
    s_add_u32 s50, s50, 1
    s_add_u32 s56, s56, 1
    s_add_u32 s52, s52, 16384
    s_cmp_eq_u32 s56, 4
    s_cselect_b32 s56, 0, s56
    s_cselect_b32 s52, s73, s52
    s_mul_i32 s59, s64, 18
    s_add_u32 s59, s59, s50
    s_cmp_lt_u32 s59, 16
    s_cselect_b32 s16, s6, s8
    s_cselect_b32 s17, s7, s9
    s_cselect_b32 s18, 2097152, s63
    s_cselect_b32 s60, 0, 16
    s_sub_u32 s59, s59, s60
    s_lshl_b32 s62, s59, 17
    s_cmp_ge_u32 s50, 18
    s_cselect_b32 s18, 0, s18
    s_cselect_b32 s54, 163840, s52
    s_add_u32 m0, s53, 0
    s_add_u32 s61, s48, 0
    buffer_load_dwordx4 v133, s[12:15], s61 offen lds
    buffer_load_dwordx4 v133, s[12:15], s61 offen offset:1024 lds
    s_add_u32 m0, s53, 2048
    s_add_u32 s61, s48, 147456
    buffer_load_dwordx4 v133, s[12:15], s61 offen lds
    buffer_load_dwordx4 v133, s[12:15], s61 offen offset:1024 lds
    s_add_u32 s49, s49, 1
    s_add_u32 s55, s55, 1
    s_add_u32 s51, s51, 16384
    s_cmp_eq_u32 s55, 3
    s_cselect_b32 s55, 0, s55
    s_cselect_b32 s51, s72, s51
    s_mul_i32 s59, s64, 18
    s_add_u32 s59, s59, s49
    s_lshl_b32 s48, s59, 11
    s_cmp_ge_u32 s49, 18
    s_cselect_b32 s14, 0, s75
    s_cselect_b32 s53, 163840, s51
    s_add_u32 m0, s54, 0
    s_add_u32 s61, s62, 0
    buffer_load_dwordx4 v134, s[16:19], s61 offen lds
    s_add_u32 m0, s54, 1024
    s_add_u32 s61, s62, 8192
    buffer_load_dwordx4 v134, s[16:19], s61 offen lds
    s_add_u32 s50, s50, 1
    s_add_u32 s56, s56, 1
    s_add_u32 s52, s52, 16384
    s_cmp_eq_u32 s56, 4
    s_cselect_b32 s56, 0, s56
    s_cselect_b32 s52, s73, s52
    s_mul_i32 s59, s64, 18
    s_add_u32 s59, s59, s50
    s_cmp_lt_u32 s59, 16
    s_cselect_b32 s16, s6, s8
    s_cselect_b32 s17, s7, s9
    s_cselect_b32 s18, 2097152, s63
    s_cselect_b32 s60, 0, 16
    s_sub_u32 s59, s59, s60
    s_lshl_b32 s62, s59, 17
    s_cmp_ge_u32 s50, 18
    s_cselect_b32 s18, 0, s18
    s_cselect_b32 s54, 163840, s52
    s_add_u32 m0, s53, 0
    s_add_u32 s61, s48, 0
    buffer_load_dwordx4 v133, s[12:15], s61 offen lds
    buffer_load_dwordx4 v133, s[12:15], s61 offen offset:1024 lds
    s_add_u32 m0, s53, 2048
    s_add_u32 s61, s48, 147456
    buffer_load_dwordx4 v133, s[12:15], s61 offen lds
    buffer_load_dwordx4 v133, s[12:15], s61 offen offset:1024 lds
    s_add_u32 s49, s49, 1
    s_add_u32 s55, s55, 1
    s_add_u32 s51, s51, 16384
    s_cmp_eq_u32 s55, 3
    s_cselect_b32 s55, 0, s55
    s_cselect_b32 s51, s72, s51
    s_mul_i32 s59, s64, 18
    s_add_u32 s59, s59, s49
    s_lshl_b32 s48, s59, 11
    s_cmp_ge_u32 s49, 18
    s_cselect_b32 s14, 0, s75
    s_cselect_b32 s53, 163840, s51
    s_add_u32 m0, s54, 0
    s_add_u32 s61, s62, 0
    buffer_load_dwordx4 v134, s[16:19], s61 offen lds
    s_add_u32 m0, s54, 1024
    s_add_u32 s61, s62, 8192
    buffer_load_dwordx4 v134, s[16:19], s61 offen lds
    s_add_u32 s50, s50, 1
    s_add_u32 s56, s56, 1
    s_add_u32 s52, s52, 16384
    s_cmp_eq_u32 s56, 4
    s_cselect_b32 s56, 0, s56
    s_cselect_b32 s52, s73, s52
    s_mul_i32 s59, s64, 18
    s_add_u32 s59, s59, s50
    s_cmp_lt_u32 s59, 16
    s_cselect_b32 s16, s6, s8
    s_cselect_b32 s17, s7, s9
    s_cselect_b32 s18, 2097152, s63
    s_cselect_b32 s60, 0, 16
    s_sub_u32 s59, s59, s60
    s_lshl_b32 s62, s59, 17
    s_cmp_ge_u32 s50, 18
    s_cselect_b32 s18, 0, s18
    s_cselect_b32 s54, 163840, s52
g2_pro2:
    s_cmp_eq_u32 s64, s46
    s_cbranch_scc0 g2_nozero
    v_mov_b32 v0, 0
    v_mov_b32 v1, 0
    v_mov_b32 v2, 0
    v_mov_b32 v3, 0
    v_mov_b32 v4, 0
    v_mov_b32 v5, 0
    v_mov_b32 v6, 0
    v_mov_b32 v7, 0
    v_mov_b32 v8, 0
    v_mov_b32 v9, 0
    v_mov_b32 v10, 0
    v_mov_b32 v11, 0
    v_mov_b32 v12, 0
    v_mov_b32 v13, 0
    v_mov_b32 v14, 0
    v_mov_b32 v15, 0
    v_mov_b32 v16, 0
    v_mov_b32 v17, 0
    v_mov_b32 v18, 0
    v_mov_b32 v19, 0
    v_mov_b32 v20, 0
    v_mov_b32 v21, 0
    v_mov_b32 v22, 0
    v_mov_b32 v23, 0
    v_mov_b32 v24, 0
    v_mov_b32 v25, 0
    v_mov_b32 v26, 0
    v_mov_b32 v27, 0
    v_mov_b32 v28, 0
    v_mov_b32 v29, 0
    v_mov_b32 v30, 0
    v_mov_b32 v31, 0
    v_mov_b32 v32, 0
    v_mov_b32 v33, 0
    v_mov_b32 v34, 0
    v_mov_b32 v35, 0
    v_mov_b32 v36, 0
    v_mov_b32 v37, 0
    v_mov_b32 v38, 0
    v_mov_b32 v39, 0
    v_mov_b32 v40, 0
    v_mov_b32 v41, 0
    v_mov_b32 v42, 0
    v_mov_b32 v43, 0
    v_mov_b32 v44, 0
    v_mov_b32 v45, 0
    v_mov_b32 v46, 0
    v_mov_b32 v47, 0
    v_mov_b32 v48, 0
    v_mov_b32 v49, 0
    v_mov_b32 v50, 0
    v_mov_b32 v51, 0
    v_mov_b32 v52, 0
    v_mov_b32 v53, 0
    v_mov_b32 v54, 0
    v_mov_b32 v55, 0
    v_mov_b32 v56, 0
    v_mov_b32 v57, 0
    v_mov_b32 v58, 0
    v_mov_b32 v59, 0
    v_mov_b32 v60, 0
    v_mov_b32 v61, 0
    v_mov_b32 v62, 0
    v_mov_b32 v63, 0
g2_nozero:
    s_mul_i32 s59, s67, 49152
    s_lshl_b32 s60, s41, 13
    s_add_u32 s59, s59, s60
    v_lshl_add_u32 v128, v135, 4, s59
    v_lshrrev_b32 v138, 2, v136
    v_lshl_add_u32 v139, v137, 3, v138
    v_lshlrev_b32 v139, 8, v139
    v_and_b32 v140, 3, v135
    v_lshl_add_u32 v139, v140, 3, v139
    v_add_u32 v139, 98304, v139
    v_and_b32 v140, 1, v137
    v_lshl_or_b32 v140, v140, 2, v138
    s_lshl_b32 s59, s42, 2
    v_xor_b32 v140, s59, v140
    v_xor_b32 v141, 0, v140
    v_lshl_add_u32 v129, v141, 5, v139
    v_xor_b32 v141, 1, v140
    v_lshl_add_u32 v130, v141, 5, v139
    v_xor_b32 v141, 2, v140
    v_lshl_add_u32 v131, v141, 5, v139
    v_xor_b32 v141, 3, v140
    v_lshl_add_u32 v132, v141, 5, v139
    s_mov_b32 s47, 0
    s_mov_b32 s57, 0
    s_mov_b32 s58, 0
    s_waitcnt vmcnt(12)
    s_barrier
    s_cmp_eq_u32 s67, 0
    s_cbranch_scc1 g2_loop
    s_barrier
.p2align 6
g2_loop:
    ds_read_b128 v[64:67], v128 offset:0
    ds_read_b128 v[72:75], v128 offset:2048
    s_add_u32 m0, s53, 0
    s_add_u32 s61, s48, 0
    buffer_load_dwordx4 v133, s[12:15], s61 offen lds
    ds_read_b128 v[80:83], v128 offset:4096
    ds_read_b128 v[88:91], v128 offset:6144
    ds_read_b64_tr_b16 v[96:97], v129 offset:0
    ds_read_b64_tr_b16 v[98:99], v129 offset:1024
    buffer_load_dwordx4 v133, s[12:15], s61 offen offset:1024 lds
    ds_read_b64_tr_b16 v[104:105], v130 offset:0
    ds_read_b64_tr_b16 v[106:107], v130 offset:1024
    ds_read_b64_tr_b16 v[112:113], v131 offset:0
    ds_read_b64_tr_b16 v[114:115], v131 offset:1024
    s_add_u32 m0, s53, 2048
    s_add_u32 s61, s48, 147456
    buffer_load_dwordx4 v133, s[12:15], s61 offen lds
    ds_read_b64_tr_b16 v[120:121], v132 offset:0
    ds_read_b64_tr_b16 v[122:123], v132 offset:1024
    ds_read_b128 v[68:71], v128 offset:1024
    ds_read_b128 v[76:79], v128 offset:3072
    buffer_load_dwordx4 v133, s[12:15], s61 offen offset:1024 lds
    ds_read_b128 v[84:87], v128 offset:5120
    ds_read_b128 v[92:95], v128 offset:7168
    ds_read_b64_tr_b16 v[100:101], v129 offset:8192
    ds_read_b64_tr_b16 v[102:103], v129 offset:9216
    s_add_u32 m0, s54, 0
    s_add_u32 s61, s62, 0
    buffer_load_dwordx4 v134, s[16:19], s61 offen lds
    ds_read_b64_tr_b16 v[108:109], v130 offset:8192
    ds_read_b64_tr_b16 v[110:111], v130 offset:9216
    ds_read_b64_tr_b16 v[116:117], v131 offset:8192
    ds_read_b64_tr_b16 v[118:119], v131 offset:9216
    s_add_u32 m0, s54, 1024
    s_add_u32 s61, s62, 8192
    buffer_load_dwordx4 v134, s[16:19], s61 offen lds
    ds_read_b64_tr_b16 v[124:125], v132 offset:8192
    ds_read_b64_tr_b16 v[126:127], v132 offset:9216
    s_waitcnt vmcnt(12) lgkmcnt(0)
    s_barrier
    s_setprio 1
    v_mfma_f32_16x16x32_bf16 v[0:3], v[96:99], v[64:67], v[0:3]
    v_mfma_f32_16x16x32_bf16 v[4:7], v[96:99], v[72:75], v[4:7]
    s_add_u32 s49, s49, 1
    s_add_u32 s55, s55, 1
    v_mfma_f32_16x16x32_bf16 v[8:11], v[96:99], v[80:83], v[8:11]
    s_add_u32 s51, s51, 16384
    s_cmp_eq_u32 s55, 3
    v_mfma_f32_16x16x32_bf16 v[12:15], v[96:99], v[88:91], v[12:15]
    s_cselect_b32 s55, 0, s55
    s_cselect_b32 s51, s72, s51
    v_mfma_f32_16x16x32_bf16 v[16:19], v[104:107], v[64:67], v[16:19]
    s_add_u32 s48, s48, 2048
    s_cmp_ge_u32 s49, 18
    v_mfma_f32_16x16x32_bf16 v[20:23], v[104:107], v[72:75], v[20:23]
    s_cselect_b32 s14, 0, s75
    s_cselect_b32 s53, 163840, s51
    v_mfma_f32_16x16x32_bf16 v[24:27], v[104:107], v[80:83], v[24:27]
    s_add_u32 s50, s50, 1
    s_add_u32 s56, s56, 1
    v_mfma_f32_16x16x32_bf16 v[28:31], v[104:107], v[88:91], v[28:31]
    s_add_u32 s52, s52, 16384
    s_cmp_eq_u32 s56, 4
    v_mfma_f32_16x16x32_bf16 v[32:35], v[112:115], v[64:67], v[32:35]
    s_cselect_b32 s56, 0, s56
    s_cselect_b32 s52, s73, s52
    v_mfma_f32_16x16x32_bf16 v[36:39], v[112:115], v[72:75], v[36:39]
    s_add_u32 s62, s62, 131072
    s_lshl_b32 s59, s64, 8
    v_mfma_f32_16x16x32_bf16 v[40:43], v[112:115], v[80:83], v[40:43]
    s_add_u32 s59, s59, s50
    s_cmp_eq_u32 s59, 16
    v_mfma_f32_16x16x32_bf16 v[44:47], v[112:115], v[88:91], v[44:47]
    s_cselect_b32 s16, s8, s16
    s_cselect_b32 s17, s9, s17
    v_mfma_f32_16x16x32_bf16 v[48:51], v[120:123], v[64:67], v[48:51]
    s_cselect_b32 s18, s63, s18
    s_cselect_b32 s62, 0, s62
    v_mfma_f32_16x16x32_bf16 v[52:55], v[120:123], v[72:75], v[52:55]
    s_cmp_ge_u32 s50, 18
    s_cselect_b32 s18, 0, s18
    v_mfma_f32_16x16x32_bf16 v[56:59], v[120:123], v[80:83], v[56:59]
    s_cselect_b32 s54, 163840, s52
    s_add_u32 s57, s57, 1
    v_mfma_f32_16x16x32_bf16 v[60:63], v[120:123], v[88:91], v[60:63]
    s_cmp_eq_u32 s57, 3
    s_cselect_b32 s57, 0, s57
    v_mfma_f32_16x16x32_bf16 v[0:3], v[100:103], v[68:71], v[0:3]
    s_cselect_b32 s59, 49152, 0
    s_sub_u32 s59, 16384, s59
    v_mfma_f32_16x16x32_bf16 v[4:7], v[100:103], v[76:79], v[4:7]
    v_add_u32 v128, s59, v128
    s_add_u32 s58, s58, 1
    v_mfma_f32_16x16x32_bf16 v[8:11], v[100:103], v[84:87], v[8:11]
    s_cmp_eq_u32 s58, 4
    s_cselect_b32 s58, 0, s58
    v_mfma_f32_16x16x32_bf16 v[12:15], v[100:103], v[92:95], v[12:15]
    s_cselect_b32 s59, 65536, 0
    s_sub_u32 s59, 16384, s59
    v_mfma_f32_16x16x32_bf16 v[16:19], v[108:111], v[68:71], v[16:19]
    v_add_u32 v129, s59, v129
    v_add_u32 v130, s59, v130
    v_mfma_f32_16x16x32_bf16 v[20:23], v[108:111], v[76:79], v[20:23]
    v_add_u32 v131, s59, v131
    v_add_u32 v132, s59, v132
    v_mfma_f32_16x16x32_bf16 v[24:27], v[108:111], v[84:87], v[24:27]
    v_mfma_f32_16x16x32_bf16 v[28:31], v[108:111], v[92:95], v[28:31]
    v_mfma_f32_16x16x32_bf16 v[32:35], v[116:119], v[68:71], v[32:35]
    v_mfma_f32_16x16x32_bf16 v[36:39], v[116:119], v[76:79], v[36:39]
    v_mfma_f32_16x16x32_bf16 v[40:43], v[116:119], v[84:87], v[40:43]
    v_mfma_f32_16x16x32_bf16 v[44:47], v[116:119], v[92:95], v[44:47]
    v_mfma_f32_16x16x32_bf16 v[48:51], v[124:127], v[68:71], v[48:51]
    v_mfma_f32_16x16x32_bf16 v[52:55], v[124:127], v[76:79], v[52:55]
    v_mfma_f32_16x16x32_bf16 v[56:59], v[124:127], v[84:87], v[56:59]
    v_mfma_f32_16x16x32_bf16 v[60:63], v[124:127], v[92:95], v[60:63]
    s_setprio 0
    s_add_u32 s47, s47, 1
    s_lshl_b32 s59, s67, 8
    s_add_u32 s59, s59, s47
    s_cmp_eq_u32 s59, 274
    s_cbranch_scc1 g2_post
    s_cmp_lt_u32 s47, 18
    s_barrier
    s_cbranch_scc1 g2_loop
g2_post:
    v_lshlrev_b32 v138, 4, v135
    s_cmp_eq_u32 s74, s46
    s_cbranch_scc1 g2_own
    s_cmp_eq_u32 s64, s46
    s_cbranch_scc0 g2_pub_done
    s_lshl_b32 s59, s66, 2
    s_add_u32 s59, s59, s46
    s_lshl_b32 s59, s59, 3
    s_add_u32 s59, s59, s40
    s_lshl_b32 s59, s59, 13
    s_add_u32 s60, s59, 4096
    v_cvt_pk_bf16_f32 v96, v0, v1
    v_cvt_pk_bf16_f32 v97, v2, v3
    v_cvt_pk_bf16_f32 v98, v4, v5
    v_cvt_pk_bf16_f32 v99, v6, v7
    buffer_store_dwordx4 v[96:99], v138, s[20:23], s59 offen offset:0 sc0 sc1
    v_cvt_pk_bf16_f32 v100, v8, v9
    v_cvt_pk_bf16_f32 v101, v10, v11
    v_cvt_pk_bf16_f32 v102, v12, v13
    v_cvt_pk_bf16_f32 v103, v14, v15
    buffer_store_dwordx4 v[100:103], v138, s[20:23], s59 offen offset:1024 sc0 sc1
    v_cvt_pk_bf16_f32 v104, v16, v17
    v_cvt_pk_bf16_f32 v105, v18, v19
    v_cvt_pk_bf16_f32 v106, v20, v21
    v_cvt_pk_bf16_f32 v107, v22, v23
    buffer_store_dwordx4 v[104:107], v138, s[20:23], s59 offen offset:2048 sc0 sc1
    v_cvt_pk_bf16_f32 v108, v24, v25
    v_cvt_pk_bf16_f32 v109, v26, v27
    v_cvt_pk_bf16_f32 v110, v28, v29
    v_cvt_pk_bf16_f32 v111, v30, v31
    buffer_store_dwordx4 v[108:111], v138, s[20:23], s59 offen offset:3072 sc0 sc1
    v_cvt_pk_bf16_f32 v112, v32, v33
    v_cvt_pk_bf16_f32 v113, v34, v35
    v_cvt_pk_bf16_f32 v114, v36, v37
    v_cvt_pk_bf16_f32 v115, v38, v39
    buffer_store_dwordx4 v[112:115], v138, s[20:23], s60 offen offset:0 sc0 sc1
    v_cvt_pk_bf16_f32 v116, v40, v41
    v_cvt_pk_bf16_f32 v117, v42, v43
    v_cvt_pk_bf16_f32 v118, v44, v45
    v_cvt_pk_bf16_f32 v119, v46, v47
    buffer_store_dwordx4 v[116:119], v138, s[20:23], s60 offen offset:1024 sc0 sc1
    v_cvt_pk_bf16_f32 v120, v48, v49
    v_cvt_pk_bf16_f32 v121, v50, v51
    v_cvt_pk_bf16_f32 v122, v52, v53
    v_cvt_pk_bf16_f32 v123, v54, v55
    buffer_store_dwordx4 v[120:123], v138, s[20:23], s60 offen offset:2048 sc0 sc1
    v_cvt_pk_bf16_f32 v124, v56, v57
    v_cvt_pk_bf16_f32 v125, v58, v59
    v_cvt_pk_bf16_f32 v126, v60, v61
    v_cvt_pk_bf16_f32 v127, v62, v63
    buffer_store_dwordx4 v[124:127], v138, s[20:23], s60 offen offset:3072 sc0 sc1
    s_branch g2_pub_done
g2_own:
    s_lshl_b32 s59, s42, 14
    v_add_u32 v141, s59, v138
    ds_write_b128 v141, v[0:3] offset:0
    ds_write_b128 v141, v[4:7] offset:1024
    ds_write_b128 v141, v[8:11] offset:2048
    ds_write_b128 v141, v[12:15] offset:3072
    ds_write_b128 v141, v[16:19] offset:4096
    ds_write_b128 v141, v[20:23] offset:5120
    ds_write_b128 v141, v[24:27] offset:6144
    ds_write_b128 v141, v[28:31] offset:7168
    ds_write_b128 v141, v[32:35] offset:8192
    ds_write_b128 v141, v[36:39] offset:9216
    ds_write_b128 v141, v[40:43] offset:10240
    ds_write_b128 v141, v[44:47] offset:11264
    ds_write_b128 v141, v[48:51] offset:12288
    ds_write_b128 v141, v[52:55] offset:13312
    ds_write_b128 v141, v[56:59] offset:14336
    ds_write_b128 v141, v[60:63] offset:15360
g2_pub_done:
    s_lshl_b32 s59, s44, 8
    s_lshl_b32 s60, s46, 6
    s_add_u32 s59, s59, s60
    s_lshl_b32 s60, s67, 5
    s_add_u32 s59, s59, s60
    v_add_u32 v141, s59, v136
    v_lshlrev_b32 v141, 11, v141
    s_lshl_b32 s59, s45, 8
    s_lshl_b32 s60, s42, 7
    s_add_u32 s59, s59, s60
    s_lshl_b32 s60, s41, 6
    s_add_u32 s59, s59, s60
    v_add_u32 v141, s59, v141
    v_lshl_add_u32 v139, v137, 3, v141
    v_and_b32 v142, 1, v137
    v_lshrrev_b32 v143, 1, v137
    v_lshl_or_b32 v142, v142, 1, v143
    v_lshl_add_u32 v140, v142, 4, v141
    s_mov_b32 s59, 32768
    buffer_load_dwordx2 v[64:65], v139, s[24:27], 0 offen offset:0
    buffer_load_dwordx2 v[66:67], v139, s[24:27], 0 offen offset:32
    buffer_load_dwordx2 v[68:69], v139, s[24:27], s59 offen offset:0
    buffer_load_dwordx2 v[70:71], v139, s[24:27], s59 offen offset:32
    s_waitcnt vmcnt(4) lgkmcnt(0)
    s_barrier
    s_cmp_eq_u32 s64, s46
    s_cbranch_scc0 g2_after_publish
    s_cmp_eq_u32 s40, 0
    s_cbranch_scc0 g2_wait_done
    s_lshl_b32 s59, s46, 2
    v_mov_b32 v141, s65
    v_mov_b32 v142, s59
    s_mov_b64 exec, 1
    buffer_store_dword v141, v142, s[36:39], s77 offen sc0 sc1
    s_mov_b32 s68, 0
g2_poll:
    buffer_load_dwordx4 v[144:147], off, s[36:39], s77 sc0 sc1
    s_waitcnt vmcnt(0)
    v_or_b32 v144, v144, v145
    v_or3_b32 v143, v144, v146, v147
    s_add_u32 s68, s68, 1
    v_readfirstlane_b32 s69, v143
    s_nop 3
    s_cmp_eq_u32 s69, 16843009
    s_cbranch_scc1 g2_poll_end
    s_cmp_lt_u32 s68, 20000
    s_cbranch_scc1 g2_poll
g2_poll_end:
    v_mov_b32 v143, s69
    v_mov_b32 v142, 65536
    ds_write_b32 v142, v143
    s_mov_b64 exec, -1
    s_waitcnt lgkmcnt(0)
g2_wait_done:
    s_barrier
    v_mov_b32 v142, 65536
    ds_read_b32 v143, v142
    s_waitcnt lgkmcnt(0)
    v_readfirstlane_b32 s69, v143
    s_nop 3
g2_after_publish:
    s_or_b32 s59, s69, s65
    s_cmp_eq_u32 s59, 0x01010101
    s_cbranch_scc1 g2_final
    s_andn2_b32 s59, 0x01010101, s59
    s_ff1_i32_b32 s59, s59
    s_lshl_b32 s60, 1, s59
    s_or_b32 s65, s65, s60
    s_lshr_b32 s64, s59, 3
    s_waitcnt vmcnt(0)
    s_barrier
    s_branch g2_gemm
g2_final:
    s_andn2_b32 s69, s69, s65
    s_lshl_b32 s59, s41, 2
    s_add_u32 s59, s59, s67
    s_lshl_b32 s59, s59, 10
    s_lshl_b32 s60, s42, 13
    s_add_u32 s61, s59, s60
    s_bitcmp1_b32 s69, 0
    s_cbranch_scc1 g2_ld0
    v_mov_b32 v0, 0
    v_mov_b32 v1, 0
    v_mov_b32 v2, 0
    v_mov_b32 v3, 0
    v_mov_b32 v4, 0
    v_mov_b32 v5, 0
    v_mov_b32 v6, 0
    v_mov_b32 v7, 0
    s_branch g2_ld0_done
g2_ld0:
    s_lshl_b32 s59, s66, 2
    s_add_u32 s59, s59, 0
    s_lshl_b32 s59, s59, 2
    s_add_u32 s59, s59, s46
    s_lshl_b32 s59, s59, 14
    s_add_u32 s59, s59, s61
    buffer_load_dwordx4 v[0:3], v138, s[20:23], s59 offen offset:0 sc0 sc1
    buffer_load_dwordx4 v[4:7], v138, s[20:23], s59 offen offset:2048 sc0 sc1
g2_ld0_done:
    s_bitcmp1_b32 s69, 8
    s_cbranch_scc1 g2_ld1
    v_mov_b32 v8, 0
    v_mov_b32 v9, 0
    v_mov_b32 v10, 0
    v_mov_b32 v11, 0
    v_mov_b32 v12, 0
    v_mov_b32 v13, 0
    v_mov_b32 v14, 0
    v_mov_b32 v15, 0
    s_branch g2_ld1_done
g2_ld1:
    s_lshl_b32 s59, s66, 2
    s_add_u32 s59, s59, 1
    s_lshl_b32 s59, s59, 2
    s_add_u32 s59, s59, s46
    s_lshl_b32 s59, s59, 14
    s_add_u32 s59, s59, s61
    buffer_load_dwordx4 v[8:11], v138, s[20:23], s59 offen offset:0 sc0 sc1
    buffer_load_dwordx4 v[12:15], v138, s[20:23], s59 offen offset:2048 sc0 sc1
g2_ld1_done:
    s_bitcmp1_b32 s69, 16
    s_cbranch_scc1 g2_ld2
    v_mov_b32 v16, 0
    v_mov_b32 v17, 0
    v_mov_b32 v18, 0
    v_mov_b32 v19, 0
    v_mov_b32 v20, 0
    v_mov_b32 v21, 0
    v_mov_b32 v22, 0
    v_mov_b32 v23, 0
    s_branch g2_ld2_done
g2_ld2:
    s_lshl_b32 s59, s66, 2
    s_add_u32 s59, s59, 2
    s_lshl_b32 s59, s59, 2
    s_add_u32 s59, s59, s46
    s_lshl_b32 s59, s59, 14
    s_add_u32 s59, s59, s61
    buffer_load_dwordx4 v[16:19], v138, s[20:23], s59 offen offset:0 sc0 sc1
    buffer_load_dwordx4 v[20:23], v138, s[20:23], s59 offen offset:2048 sc0 sc1
g2_ld2_done:
    s_bitcmp1_b32 s69, 24
    s_cbranch_scc1 g2_ld3
    v_mov_b32 v24, 0
    v_mov_b32 v25, 0
    v_mov_b32 v26, 0
    v_mov_b32 v27, 0
    v_mov_b32 v28, 0
    v_mov_b32 v29, 0
    v_mov_b32 v30, 0
    v_mov_b32 v31, 0
    s_branch g2_ld3_done
g2_ld3:
    s_lshl_b32 s59, s66, 2
    s_add_u32 s59, s59, 3
    s_lshl_b32 s59, s59, 2
    s_add_u32 s59, s59, s46
    s_lshl_b32 s59, s59, 14
    s_add_u32 s59, s59, s61
    buffer_load_dwordx4 v[24:27], v138, s[20:23], s59 offen offset:0 sc0 sc1
    buffer_load_dwordx4 v[28:31], v138, s[20:23], s59 offen offset:2048 sc0 sc1
g2_ld3_done:
    s_lshl_b32 s59, s41, 3
    s_lshl_b32 s60, s67, 1
    s_add_u32 s59, s59, s60
    s_lshl_b32 s59, s59, 10
    s_lshl_b32 s60, s42, 14
    s_add_u32 s59, s59, s60
    v_add_u32 v141, s59, v138
    ds_read_b128 v[96:99], v141 offset:0
    ds_read_b128 v[100:103], v141 offset:1024
    ds_read_b128 v[104:107], v141 offset:4096
    ds_read_b128 v[108:111], v141 offset:5120
    s_waitcnt vmcnt(0) lgkmcnt(0)
    v_lshlrev_b32 v146, 16, v0
    v_and_b32 v147, 0xffff0000, v0
    v_lshlrev_b32 v148, 16, v1
    v_and_b32 v149, 0xffff0000, v1
    v_pk_add_f32 v[96:97], v[96:97], v[146:147]
    v_pk_add_f32 v[98:99], v[98:99], v[148:149]
    v_lshlrev_b32 v146, 16, v8
    v_and_b32 v147, 0xffff0000, v8
    v_lshlrev_b32 v148, 16, v9
    v_and_b32 v149, 0xffff0000, v9
    v_pk_add_f32 v[96:97], v[96:97], v[146:147]
    v_pk_add_f32 v[98:99], v[98:99], v[148:149]
    v_lshlrev_b32 v146, 16, v16
    v_and_b32 v147, 0xffff0000, v16
    v_lshlrev_b32 v148, 16, v17
    v_and_b32 v149, 0xffff0000, v17
    v_pk_add_f32 v[96:97], v[96:97], v[146:147]
    v_pk_add_f32 v[98:99], v[98:99], v[148:149]
    v_lshlrev_b32 v146, 16, v24
    v_and_b32 v147, 0xffff0000, v24
    v_lshlrev_b32 v148, 16, v25
    v_and_b32 v149, 0xffff0000, v25
    v_pk_add_f32 v[96:97], v[96:97], v[146:147]
    v_pk_add_f32 v[98:99], v[98:99], v[148:149]
    v_lshlrev_b32 v146, 16, v64
    v_and_b32 v147, 0xffff0000, v64
    v_lshlrev_b32 v148, 16, v65
    v_and_b32 v149, 0xffff0000, v65
    v_pk_add_f32 v[96:97], v[96:97], v[146:147]
    v_pk_add_f32 v[98:99], v[98:99], v[148:149]
    v_cvt_pk_bf16_f32 v80, v96, v97
    v_cvt_pk_bf16_f32 v81, v98, v99
    v_lshlrev_b32 v146, 16, v4
    v_and_b32 v147, 0xffff0000, v4
    v_lshlrev_b32 v148, 16, v5
    v_and_b32 v149, 0xffff0000, v5
    v_pk_add_f32 v[104:105], v[104:105], v[146:147]
    v_pk_add_f32 v[106:107], v[106:107], v[148:149]
    v_lshlrev_b32 v146, 16, v12
    v_and_b32 v147, 0xffff0000, v12
    v_lshlrev_b32 v148, 16, v13
    v_and_b32 v149, 0xffff0000, v13
    v_pk_add_f32 v[104:105], v[104:105], v[146:147]
    v_pk_add_f32 v[106:107], v[106:107], v[148:149]
    v_lshlrev_b32 v146, 16, v20
    v_and_b32 v147, 0xffff0000, v20
    v_lshlrev_b32 v148, 16, v21
    v_and_b32 v149, 0xffff0000, v21
    v_pk_add_f32 v[104:105], v[104:105], v[146:147]
    v_pk_add_f32 v[106:107], v[106:107], v[148:149]
    v_lshlrev_b32 v146, 16, v28
    v_and_b32 v147, 0xffff0000, v28
    v_lshlrev_b32 v148, 16, v29
    v_and_b32 v149, 0xffff0000, v29
    v_pk_add_f32 v[104:105], v[104:105], v[146:147]
    v_pk_add_f32 v[106:107], v[106:107], v[148:149]
    v_lshlrev_b32 v146, 16, v66
    v_and_b32 v147, 0xffff0000, v66
    v_lshlrev_b32 v148, 16, v67
    v_and_b32 v149, 0xffff0000, v67
    v_pk_add_f32 v[104:105], v[104:105], v[146:147]
    v_pk_add_f32 v[106:107], v[106:107], v[148:149]
    v_cvt_pk_bf16_f32 v82, v104, v105
    v_cvt_pk_bf16_f32 v83, v106, v107
    s_mov_b32 s60, 32768
    s_nop 0
    v_permlane16_swap_b32 v80, v82
    v_permlane16_swap_b32 v81, v83
    s_nop 1
    buffer_store_dwordx4 v[80:83], v140, s[32:35], 0 offen
    v_lshlrev_b32 v146, 16, v2
    v_and_b32 v147, 0xffff0000, v2
    v_lshlrev_b32 v148, 16, v3
    v_and_b32 v149, 0xffff0000, v3
    v_pk_add_f32 v[100:101], v[100:101], v[146:147]
    v_pk_add_f32 v[102:103], v[102:103], v[148:149]
    v_lshlrev_b32 v146, 16, v10
    v_and_b32 v147, 0xffff0000, v10
    v_lshlrev_b32 v148, 16, v11
    v_and_b32 v149, 0xffff0000, v11
    v_pk_add_f32 v[100:101], v[100:101], v[146:147]
    v_pk_add_f32 v[102:103], v[102:103], v[148:149]
    v_lshlrev_b32 v146, 16, v18
    v_and_b32 v147, 0xffff0000, v18
    v_lshlrev_b32 v148, 16, v19
    v_and_b32 v149, 0xffff0000, v19
    v_pk_add_f32 v[100:101], v[100:101], v[146:147]
    v_pk_add_f32 v[102:103], v[102:103], v[148:149]
    v_lshlrev_b32 v146, 16, v26
    v_and_b32 v147, 0xffff0000, v26
    v_lshlrev_b32 v148, 16, v27
    v_and_b32 v149, 0xffff0000, v27
    v_pk_add_f32 v[100:101], v[100:101], v[146:147]
    v_pk_add_f32 v[102:103], v[102:103], v[148:149]
    v_lshlrev_b32 v146, 16, v68
    v_and_b32 v147, 0xffff0000, v68
    v_lshlrev_b32 v148, 16, v69
    v_and_b32 v149, 0xffff0000, v69
    v_pk_add_f32 v[100:101], v[100:101], v[146:147]
    v_pk_add_f32 v[102:103], v[102:103], v[148:149]
    v_cvt_pk_bf16_f32 v84, v100, v101
    v_cvt_pk_bf16_f32 v85, v102, v103
    v_lshlrev_b32 v146, 16, v6
    v_and_b32 v147, 0xffff0000, v6
    v_lshlrev_b32 v148, 16, v7
    v_and_b32 v149, 0xffff0000, v7
    v_pk_add_f32 v[108:109], v[108:109], v[146:147]
    v_pk_add_f32 v[110:111], v[110:111], v[148:149]
    v_lshlrev_b32 v146, 16, v14
    v_and_b32 v147, 0xffff0000, v14
    v_lshlrev_b32 v148, 16, v15
    v_and_b32 v149, 0xffff0000, v15
    v_pk_add_f32 v[108:109], v[108:109], v[146:147]
    v_pk_add_f32 v[110:111], v[110:111], v[148:149]
    v_lshlrev_b32 v146, 16, v22
    v_and_b32 v147, 0xffff0000, v22
    v_lshlrev_b32 v148, 16, v23
    v_and_b32 v149, 0xffff0000, v23
    v_pk_add_f32 v[108:109], v[108:109], v[146:147]
    v_pk_add_f32 v[110:111], v[110:111], v[148:149]
    v_lshlrev_b32 v146, 16, v30
    v_and_b32 v147, 0xffff0000, v30
    v_lshlrev_b32 v148, 16, v31
    v_and_b32 v149, 0xffff0000, v31
    v_pk_add_f32 v[108:109], v[108:109], v[146:147]
    v_pk_add_f32 v[110:111], v[110:111], v[148:149]
    v_lshlrev_b32 v146, 16, v70
    v_and_b32 v147, 0xffff0000, v70
    v_lshlrev_b32 v148, 16, v71
    v_and_b32 v149, 0xffff0000, v71
    v_pk_add_f32 v[108:109], v[108:109], v[146:147]
    v_pk_add_f32 v[110:111], v[110:111], v[148:149]
    v_cvt_pk_bf16_f32 v86, v108, v109
    v_cvt_pk_bf16_f32 v87, v110, v111
    s_mov_b32 s60, 32768
    s_nop 0
    v_permlane16_swap_b32 v84, v86
    v_permlane16_swap_b32 v85, v87
    s_nop 1
    buffer_store_dwordx4 v[84:87], v140, s[32:35], s60 offen
g2_exit:
    s_endpgm
.section .rodata,"a"
.p2align 6

.amdhsa_kernel g1_kernel
  .amdhsa_next_free_vgpr 256
  .amdhsa_next_free_sgpr 102
  .amdhsa_accum_offset 256
  .amdhsa_group_segment_fixed_size 0
  .amdhsa_kernarg_size 72
  .amdhsa_user_sgpr_count 2
  .amdhsa_user_sgpr_kernarg_segment_ptr 1
  .amdhsa_system_sgpr_workgroup_id_x 1
.end_amdhsa_kernel
.p2align 6

.amdhsa_kernel g2_kernel
  .amdhsa_next_free_vgpr 160
  .amdhsa_next_free_sgpr 80
  .amdhsa_accum_offset 160
  .amdhsa_group_segment_fixed_size 0
  .amdhsa_kernarg_size 72
  .amdhsa_user_sgpr_count 2
  .amdhsa_user_sgpr_kernarg_segment_ptr 1
  .amdhsa_system_sgpr_workgroup_id_x 1
.end_amdhsa_kernel
```
